```python
import torch

def _softmax(x, axis=-1):
    return torch.softmax(x, dim=axis)
def _gelu(x):
    return torch.nn.functional.gelu(x, approximate="tanh")
def _silu(x):
    return torch.nn.functional.silu(x)
def _sigmoid(x):
    return torch.sigmoid(x)
def _layernorm(x, axis=-1, eps=1e-5):
    m = x.mean(dim=axis, keepdim=True)
    v = x.var(dim=axis, keepdim=True, unbiased=False)
    return (x - m) / torch.sqrt(v + eps)
def _scatter_add(tgt, idx, src, axis=0):
    return tgt.clone().index_add_(axis, idx, src)
def _segment_sum(src, seg, n):
    out = torch.zeros((n,) + src.shape[1:], dtype=src.dtype)
    return out.index_add_(0, seg, src)
def _pad(x, pw):
    flat = tuple(v for pair in reversed(pw) for v in pair)
    return torch.nn.functional.pad(x, flat)

kernel_name = 'gated_mix__ssm_conv_s4__glu_gated_glu__prompt'

def setup_inputs():

    _w = (lambda a: (lambda t: t.to(torch.bfloat16) if t.is_floating_point() else t)(torch.as_tensor(a)))
    def _A_setup():
        B, L, D, N = 1, 2048, 512, 128
        A_re = -(lambda _x: torch.exp(torch.as_tensor(_x)))((lambda *s: torch.randn(*s, dtype=torch.bfloat16) * 6.4)(D, N))
        A_im = torch.pi * (lambda *s: torch.randn(*s, dtype=torch.bfloat16) * 0.1)(D, N)
        B_re = (lambda *s: torch.randn(*s, dtype=torch.bfloat16) * 0.2)(D, N)
        B_im = (lambda *s: torch.randn(*s, dtype=torch.bfloat16) * 0.2)(D, N)
        C_re = (lambda *s: torch.randn(*s, dtype=torch.bfloat16) * 0.2)(D, N)
        C_im = (lambda *s: torch.randn(*s, dtype=torch.bfloat16) * 0.2)(D, N)
        log_dt = (lambda *s: torch.randn(*s, dtype=torch.bfloat16) * 0.1)(D) * 0.5 - 4.0
        Dskip = (lambda *s: torch.randn(*s, dtype=torch.bfloat16) * 0.1)(D)
        return {
            "u": _w((lambda *s: torch.randn(*s, dtype=torch.bfloat16) * 0.05)(B, L, D)),
            "A_re": _w(A_re),
            "A_im": _w(A_im),
            "B_re": _w(B_re),
            "B_im": _w(B_im),
            "C_re": _w(C_re),
            "C_im": _w(C_im),
            "log_dt": _w(log_dt),
            "Dskip": _w(Dskip),
        }
    _A_in = _A_setup()

    def _B_setup():
        B, S, D, F = 1, 2048, 512, 1792
        return {
            "x": _w((lambda *s: torch.randn(*s, dtype=torch.bfloat16) * 0.05)(B, S, D)),
            "w_gate": _w((lambda *s: torch.randn(*s, dtype=torch.bfloat16) * 0.4)(D, F)),
            "w_up": _w((lambda *s: torch.randn(*s, dtype=torch.bfloat16) * 0.05)(D, F)),
            "w_down": _w((lambda *s: torch.randn(*s, dtype=torch.bfloat16) * 0.05)(F, D)),
        }
    _B_in = _B_setup()

    return {
        "A_u": _A_in["u"],
        "A_A_re": _A_in["A_re"],
        "A_A_im": _A_in["A_im"],
        "A_B_re": _A_in["B_re"],
        "A_B_im": _A_in["B_im"],
        "A_C_re": _A_in["C_re"],
        "A_C_im": _A_in["C_im"],
        "A_log_dt": _A_in["log_dt"],
        "A_Dskip": _A_in["Dskip"],
        "B_x": _B_in["x"],
        "B_w_gate": _B_in["w_gate"],
        "B_w_up": _B_in["w_up"],
        "B_w_down": _B_in["w_down"],
        "gate_w": _w((lambda *s: torch.randn(*s, dtype=torch.bfloat16) * 0.05)(512) * 16.0),
    }

def reference(A_u, A_A_re, A_A_im, A_B_re, A_B_im, A_C_re, A_C_im, A_log_dt, A_Dskip, B_x, B_w_gate, B_w_up, B_w_down, gate_w):
    def _A_ref(u, A_re, A_im, B_re, B_im, C_re, C_im, log_dt, Dskip):
        Bsz, L, D = u.shape
        dt = torch.exp(log_dt)[:, None]
        A = A_re + 1j * A_im
        Bc = B_re + 1j * B_im
        Cc = C_re + 1j * C_im
        logdA = dt * A
        dB = dt * Bc
        l = (lambda x, dt: x.to(dt))(torch.arange(L), A_re.dtype)
        P = torch.exp(logdA[:, :, None] * l[None, None, :])
        K = torch.einsum("dn,dnl,dn->dl", Cc, P, dB).real
        L2 = 2 * L
        Kp = _pad(K, ((0, 0), (0, L)))
        up = (lambda x, *d: x.permute(*d))(u, 0, 2, 1)
        up = _pad(up, ((0, 0), (0, 0), (0, L)))
        Kf = (lambda x, axes=(-2,-1): torch.fft.rfft2(x.float(), dim=axes))(Kp[:, None, :], axes=(-2, -1))
        Uf = (lambda x, axes=(-2,-1): torch.fft.rfft2(x.float(), dim=axes))(up[:, :, None, :], axes=(-2, -1))
        Yf = Uf * Kf[None, :, :, :]
        y = (lambda x, s, axes=(-2,-1): torch.fft.irfft2(x, s=s, dim=axes).to(torch.bfloat16))(Yf, (1, L2), axes=(-2, -1))[:, :, 0, :L]
        y = (lambda x, *d: x.permute(*d))(y, 0, 2, 1) + u * Dskip[None, None, :]
        return y

    def _B_ref(x, w_gate, w_up, w_down):
        g = torch.einsum("bsd,df->bsf", x, w_gate)
        u = torch.einsum("bsd,df->bsf", x, w_up)
        h = _sigmoid(g) * u
        return torch.einsum("bsf,fd->bsd", h, w_down)

    x = A_u
    g = _sigmoid((x * gate_w).sum(-1, keepdims=True))
    a = _A_ref(x, A_A_re, A_A_im, A_B_re, A_B_im, A_C_re, A_C_im, A_log_dt, A_Dskip)
    b = _B_ref(x, B_w_gate, B_w_up, B_w_down)
    return g * a + (1 - g) * b
```

```asm
; @launch grid=(256,1,1) block=(512,1,1) lds=158016
.amdgcn_target "amdgcn-amd-amdhsa--gfx950"
.text
.globl gated_mix__ssm_conv_s4__glu_gated_glu__prompt_kernel
.p2align 8
.type gated_mix__ssm_conv_s4__glu_gated_glu__prompt_kernel,@function
gated_mix__ssm_conv_s4__glu_gated_glu__prompt_kernel:
    s_cmp_ge_u32 s2, 256
    s_cbranch_scc1 L_end
    s_load_dwordx16 s[36:51], s[0:1], 0
    s_load_dwordx16 s[52:67], s[0:1], 64
    s_load_dwordx2 s[16:17], s[0:1], 128
    s_getpc_b64 s[78:79]
E_pc:
    s_sub_u32 s78, s78, E_pc-gated_mix__ssm_conv_s4__glu_gated_glu__prompt_kernel
    s_subb_u32 s79, s79, 0
    s_lshr_b32 s34, s2, 3
    s_lshl_b32 s34, s34, 10
    v_lshlrev_b32 v3, 7, v0
    v_add_u32 v3, s34, v3
    v_and_b32 v3, 0x7fff, v3
    v_min_u32 v3, L_end-gated_mix__ssm_conv_s4__glu_gated_glu__prompt_kernel, v3
    v_cmp_gt_u32 vcc, 8, v0
    s_nop 0
    s_and_saveexec_b64 s[70:71], vcc
    s_cbranch_execz E_nopf
    global_load_dword v255, v3, s[78:79]
E_nopf:
    s_mov_b64 exec, -1
    v_lshrrev_b32 v2, 6, v0
    v_and_b32 v1, 63, v0
    v_readfirstlane_b32 s28, v2
    s_nop 0
    s_cmp_ge_u32 s28, 4
    s_cbranch_scc1 E_l
    v_and_b32 v2, 255, v0
    s_lshl_b32 s34, s2, 8
    v_add_lshl_u32 v2, v2, s34, 1
    s_lshr_b32 s34, s28, 1
    s_lshl_b32 s35, s2, 1
    s_add_u32 s34, s34, s35
    s_lshl_b32 s34, s34, 1
    v_mov_b32 v3, s34
    s_waitcnt lgkmcnt(0)
    global_load_ushort v34, v3, s[50:51]
    global_load_ushort v52, v3, s[52:53]
    global_load_ushort v28, v2, s[38:39]
    global_load_ushort v29, v2, s[40:41]
    global_load_ushort v30, v2, s[42:43]
    global_load_ushort v31, v2, s[44:45]
    global_load_ushort v32, v2, s[46:47]
    global_load_ushort v33, v2, s[48:49]
E_l:
    s_mov_b32 s18, 25165824
    s_mov_b32 s19, 0x20000
    s_and_b32 s34, s2, 7
    s_lshr_b32 s35, s2, 3
    s_cmp_ge_u32 s35, 28
    s_cselect_b32 s31, 1, 0
    s_mul_i32 s29, s35, 37
    s_lshr_b32 s29, s29, 8
    s_mul_i32 s30, s29, 7
    s_sub_u32 s30, s35, s30
    s_lshr_b32 s69, s34, 1
    s_lshl_b32 s69, s69, 2
    s_add_u32 s29, s29, s69
    s_and_b32 s69, s34, 1
    s_mul_i32 s69, s69, 7
    s_add_u32 s30, s30, s69
    s_lshl_b32 s32, s34, 2
    s_lshr_b32 s69, s2, 6
    s_add_u32 s32, s32, s69
    s_and_b32 s33, s35, 7
    s_mul_i32 s69, s35, 37
    s_lshr_b32 s69, s69, 8
    s_mul_i32 s33, s69, 7
    s_sub_u32 s33, s35, s33
    s_cmp_lg_u32 s31, 0
    s_cselect_b32 s69, s33, s69
    s_lshl_b32 s32, s34, 2
    s_add_u32 s32, s32, s69
    s_cmp_ge_u32 s33, 3
    s_addc_u32 s33, s33, 0
    s_cmp_lg_u32 s31, 0
    s_cselect_b32 s33, 3, s33
    s_and_b32 s69, s34, 3
    s_mul_i32 s69, s69, 28
    s_add_u32 s69, s69, s35
    s_lshr_b32 s30, s69, 3
    s_and_b32 s29, s69, 7
    s_and_b32 s69, s34, 4
    s_lshl_b32 s69, s69, 1
    s_add_u32 s29, s29, s69
    v_mov_b32 v7, 157952
    v_mov_b32 v8, 1
    s_cmp_lt_u32 s28, 4
    s_cbranch_scc0 L_role
C_role:
    s_setprio 2
    v_mov_b32 v25, 0
    v_lshlrev_b32 v17, 4, v1
    v_lshlrev_b32 v252, 7, v1
    s_add_u32 s34, s2, s28
    s_cmp_lg_u32 s34, 0
    s_cbranch_scc1 C_notok
    s_memrealtime s[78:79]
    s_waitcnt lgkmcnt(0)
    s_mul_i32 s34, s78, 0x9e3779b1
    s_or_b32 s34, s34, 1
    v_mov_b32 v4, s34
    s_mov_b64 exec, 1
    global_store_dword v25, v4, s[66:67] sc1
    s_mov_b64 exec, -1
C_notok:
    v_mov_b64 v[96:97], 0
    v_mov_b64 v[98:99], 0
    s_mul_i32 s34, s28, 2304
    s_add_u32 s34, s34, 148736
    v_add_u32 v4, s34, v17
    s_mov_b64 exec, 0xff
    ds_write_b128 v4, v[96:99]
    ds_write_b128 v4, v[96:99] offset:1152
    s_mov_b64 exec, 1
    ds_write_b128 v7, v[96:99]
    ds_write_b128 v7, v[96:99] offset:16
    s_mov_b64 exec, -1
    s_cmp_eq_u32 s31, 0
    s_cbranch_scc1 C_nob
    s_barrier
C_nob:
    v_and_b32 v37, 15, v1
    v_lshrrev_b32 v38, 4, v1
    v_lshlrev_b32 v39, 4, v1
    s_mul_i32 s35, s28, 4352
    s_add_u32 s35, s35, 114688
    v_add_u32 v40, s35, v39
    v_lshlrev_b32 v41, 7, v38
    v_bfe_u32 v4, v1, 2, 2
    v_lshl_add_u32 v41, v4, 4, v41
    v_and_b32 v5, 1, v1
    v_lshl_add_u32 v41, v5, 3, v41
    v_bfe_u32 v4, v1, 1, 1
    s_mul_i32 s34, s28, 4160
    s_add_u32 s34, s34, 132096
    v_add_u32 v50, s34, v39
    v_mul_u32_u24 v5, 1040, v4
    v_add3_u32 v51, v41, v5, s34
    v_mul_u32_u24 v5, 1088, v4
    v_add3_u32 v41, v41, v5, s35
    s_mul_i32 s35, s28, 4352
    s_add_u32 s35, s35, 114688
    v_lshlrev_b32 v42, 6, v37
    v_lshl_add_u32 v42, v38, 4, v42
    v_add_u32 v42, s35, v42
    v_lshlrev_b32 v43, 5, v37
    v_cmp_gt_u32 vcc, 2, v38
    v_lshl_add_u32 v43, v38, 4, v43
    v_lshlrev_b32 v44, 4, v37
    v_lshl_add_u32 v44, v38, 8, v44
    v_cndmask_b32 v43, v44, v43, vcc
    v_add_u32 v43, s35, v43
    v_lshlrev_b32 v44, 3, v37
    v_lshl_add_u32 v44, v38, 8, v44
    v_add_u32 v44, s35, v44
    s_and_b32 s69, s28, 2
    s_mul_i32 s35, s69, 4160
    s_mul_i32 s69, s69, 4352
    s_add_u32 s69, s69, 114688
    s_add_u32 s35, s35, 132128
    v_lshlrev_b32 v48, 3, v1
    v_add_u32 v46, s69, v48
    v_add_u32 v48, s35, v48
    v_add_u32 v49, 4164, v48
    v_add_u32 v45, s69, v39
    v_lshlrev_b32 v47, 2, v1
    v_add_u32 v47, s69, v47
    v_and_b32 v5, 1, v1
    v_cmp_eq_u32 vcc, 0, v5
    s_bitcmp0_b32 s28, 0
    s_cbranch_scc1 CK_xa0
    v_add_u32 v46, 1, v1
    v_lshrrev_b32 v46, 1, v46
    v_xor_b32 v45, -1, v5
    v_and_b32 v45, v45, v46
    v_lshlrev_b32 v45, 2, v45
    v_lshlrev_b32 v46, 2, v46
    v_add_u32 v45, s69, v45
    v_add_u32 v46, s69, v46
CK_xa0:
    v_and_b32 v2, 31, v1
    v_bfe_u32 v3, v1, 1, 3
    v_lshrrev_b32 v4, 5, v1
    v_xor_b32 v3, v3, v4
    v_lshlrev_b32 v3, 4, v3
    v_lshl_add_u32 v3, v2, 7, v3
    s_and_b32 s34, s28, 1
    s_lshl_b32 s34, s34, 13
    v_add_u32 v9, s34, v3
    v_xor_b32 v10, 32, v9
    v_xor_b32 v11, 64, v9
    v_xor_b32 v12, 96, v9
    v_bfe_u32 v2, v1, 2, 2
    s_and_b32 s34, s28, 2
    v_xor_b32 v3, s34, v2
    v_lshlrev_b32 v3, 6, v3
    v_lshl_add_u32 v2, v4, 3, v2
    v_lshl_add_u32 v18, v2, 8, v3
    v_bfe_u32 v2, v1, 4, 1
    v_lshl_add_u32 v18, v2, 5, v18
    v_and_b32 v2, 3, v1
    v_lshl_add_u32 v18, v2, 3, v18
    v_xor_b32 v19, 64, v18
    s_mov_b32 s70, 1
    v_add_u32 v13, 81920, v9
    v_add_u32 v14, 81920, v10
    v_add_u32 v15, 81920, v11
    v_add_u32 v16, 81920, v12
    s_waitcnt vmcnt(0)
    v_lshlrev_b32 v34, 16, v34
    v_mul_f32 v34, 1069066811, v34
    v_exp_f32 v34, v34
    v_lshlrev_b32 v28, 16, v28
    v_lshlrev_b32 v29, 16, v29
    v_lshlrev_b32 v30, 16, v30
    v_lshlrev_b32 v31, 16, v31
    v_lshlrev_b32 v32, 16, v32
    v_lshlrev_b32 v33, 16, v33
    v_lshlrev_b32 v52, 16, v52
    v_cvt_pk_bf16_f32 v34, v34, v34
    v_lshlrev_b32 v34, 16, v34
    v_mul_f32 v35, v34, v28
    v_mul_f32 v36, v34, v29
    v_mul_f32 v30, v34, v30
    v_mul_f32 v31, v34, v31
    v_mul_f32 v35, 1069066811, v35
    v_mul_f32 v36, 1042479491, v36
    v_pk_mul_f32 v[58:59], v[32:33], v[30:31] op_sel_hi:[0,1]
    v_pk_fma_f32 v[58:59], v[32:33], v[30:31], v[58:59] op_sel:[1,1,0] op_sel_hi:[1,0,1] neg_lo:[0,1,0]
    v_mul_f32 v74, 0x41800000, v35
    v_mul_f32 v75, 0x41800000, v36
    v_mul_f32 v76, 0x43800000, v35
    v_mul_f32 v77, 0x43800000, v36
    v_exp_f32 v72, v35
    v_fract_f32 v73, v36
    v_exp_f32 v74, v74
    v_fract_f32 v75, v75
    v_exp_f32 v76, v76
    v_fract_f32 v77, v77
    v_cos_f32 v60, v73
    v_sin_f32 v61, v73
    v_cos_f32 v68, v75
    v_sin_f32 v69, v75
    v_cos_f32 v70, v77
    v_sin_f32 v71, v77
    v_mul_f32 v60, v72, v60
    v_mul_f32 v61, v72, v61
    v_mul_f32 v68, v74, v68
    v_mul_f32 v69, v74, v69
    v_mul_f32 v70, v76, v70
    v_mul_f32 v71, v76, v71
    v_pk_mul_f32 v[74:75], v[58:59], v[68:69] op_sel_hi:[0,1]
    v_cvt_pk_bf16_f32 v120, 1.0, v60
    v_pk_fma_f32 v[74:75], v[58:59], v[68:69], v[74:75] op_sel:[1,1,0] op_sel_hi:[1,0,1] neg_lo:[0,1,0]
    v_cvt_pk_bf16_f32 v128, 0, v61
    v_cvt_pk_bf16_f32 v104, v58, v74
    v_pk_mul_f32 v[62:63], v[60:61], v[60:61] op_sel_hi:[0,1]
    v_cvt_pk_bf16_f32 v112, -v59, -v75
    v_pk_fma_f32 v[62:63], v[60:61], v[60:61], v[62:63] op_sel:[1,1,0] op_sel_hi:[1,0,1] neg_lo:[0,1,0]
    v_pk_mul_f32 v[72:73], v[74:75], v[68:69] op_sel_hi:[0,1]
    v_pk_mul_f32 v[78:79], v[62:63], v[60:61] op_sel_hi:[0,1]
    v_pk_fma_f32 v[72:73], v[74:75], v[68:69], v[72:73] op_sel:[1,1,0] op_sel_hi:[1,0,1] neg_lo:[0,1,0]
    v_pk_fma_f32 v[78:79], v[62:63], v[60:61], v[78:79] op_sel:[1,1,0] op_sel_hi:[1,0,1] neg_lo:[0,1,0]
    v_pk_mul_f32 v[74:75], v[72:73], v[68:69] op_sel_hi:[0,1]
    v_cvt_pk_bf16_f32 v121, v62, v78
    v_pk_fma_f32 v[74:75], v[72:73], v[68:69], v[74:75] op_sel:[1,1,0] op_sel_hi:[1,0,1] neg_lo:[0,1,0]
    v_cvt_pk_bf16_f32 v129, v63, v79
    v_cvt_pk_bf16_f32 v105, v72, v74
    v_pk_mul_f32 v[64:65], v[78:79], v[60:61] op_sel_hi:[0,1]
    v_cvt_pk_bf16_f32 v113, -v73, -v75
    v_pk_fma_f32 v[64:65], v[78:79], v[60:61], v[64:65] op_sel:[1,1,0] op_sel_hi:[1,0,1] neg_lo:[0,1,0]
    v_pk_mul_f32 v[72:73], v[74:75], v[68:69] op_sel_hi:[0,1]
    v_pk_mul_f32 v[78:79], v[64:65], v[60:61] op_sel_hi:[0,1]
    v_pk_fma_f32 v[72:73], v[74:75], v[68:69], v[72:73] op_sel:[1,1,0] op_sel_hi:[1,0,1] neg_lo:[0,1,0]
    v_pk_fma_f32 v[78:79], v[64:65], v[60:61], v[78:79] op_sel:[1,1,0] op_sel_hi:[1,0,1] neg_lo:[0,1,0]
    v_pk_mul_f32 v[74:75], v[72:73], v[68:69] op_sel_hi:[0,1]
    v_cvt_pk_bf16_f32 v122, v64, v78
    v_pk_fma_f32 v[74:75], v[72:73], v[68:69], v[74:75] op_sel:[1,1,0] op_sel_hi:[1,0,1] neg_lo:[0,1,0]
    v_cvt_pk_bf16_f32 v130, v65, v79
    v_cvt_pk_bf16_f32 v106, v72, v74
    v_pk_mul_f32 v[76:77], v[78:79], v[60:61] op_sel_hi:[0,1]
    v_cvt_pk_bf16_f32 v114, -v73, -v75
    v_pk_fma_f32 v[76:77], v[78:79], v[60:61], v[76:77] op_sel:[1,1,0] op_sel_hi:[1,0,1] neg_lo:[0,1,0]
    v_pk_mul_f32 v[72:73], v[74:75], v[68:69] op_sel_hi:[0,1]
    v_pk_mul_f32 v[78:79], v[76:77], v[60:61] op_sel_hi:[0,1]
    v_pk_fma_f32 v[72:73], v[74:75], v[68:69], v[72:73] op_sel:[1,1,0] op_sel_hi:[1,0,1] neg_lo:[0,1,0]
    v_pk_fma_f32 v[78:79], v[76:77], v[60:61], v[78:79] op_sel:[1,1,0] op_sel_hi:[1,0,1] neg_lo:[0,1,0]
    v_pk_mul_f32 v[74:75], v[72:73], v[68:69] op_sel_hi:[0,1]
    v_cvt_pk_bf16_f32 v123, v76, v78
    v_pk_fma_f32 v[74:75], v[72:73], v[68:69], v[74:75] op_sel:[1,1,0] op_sel_hi:[1,0,1] neg_lo:[0,1,0]
    v_cvt_pk_bf16_f32 v131, v77, v79
    v_cvt_pk_bf16_f32 v107, v72, v74
    v_cvt_pk_bf16_f32 v115, -v73, -v75
    ds_write_b128 v40, v[104:107] offset:0
    v_pk_mul_f32 v[72:73], v[74:75], v[68:69] op_sel_hi:[0,1]
    v_pk_mul_f32 v[66:67], v[78:79], v[60:61] op_sel_hi:[0,1]
    v_pk_fma_f32 v[72:73], v[74:75], v[68:69], v[72:73] op_sel:[1,1,0] op_sel_hi:[1,0,1] neg_lo:[0,1,0]
    v_pk_fma_f32 v[66:67], v[78:79], v[60:61], v[66:67] op_sel:[1,1,0] op_sel_hi:[1,0,1] neg_lo:[0,1,0]
    v_pk_mul_f32 v[74:75], v[72:73], v[68:69] op_sel_hi:[0,1]
    v_pk_mul_f32 v[78:79], v[66:67], v[60:61] op_sel_hi:[0,1]
    v_pk_fma_f32 v[74:75], v[72:73], v[68:69], v[74:75] op_sel:[1,1,0] op_sel_hi:[1,0,1] neg_lo:[0,1,0]
    v_pk_fma_f32 v[78:79], v[66:67], v[60:61], v[78:79] op_sel:[1,1,0] op_sel_hi:[1,0,1] neg_lo:[0,1,0]
    v_cvt_pk_bf16_f32 v108, v72, v74
    v_cvt_pk_bf16_f32 v124, v66, v78
    v_cvt_pk_bf16_f32 v116, -v73, -v75
    v_cvt_pk_bf16_f32 v132, v67, v79
    ds_write_b128 v40, v[112:115] offset:2176
    v_pk_mul_f32 v[72:73], v[74:75], v[68:69] op_sel_hi:[0,1]
    v_pk_mul_f32 v[76:77], v[78:79], v[60:61] op_sel_hi:[0,1]
    v_pk_fma_f32 v[72:73], v[74:75], v[68:69], v[72:73] op_sel:[1,1,0] op_sel_hi:[1,0,1] neg_lo:[0,1,0]
    v_pk_fma_f32 v[76:77], v[78:79], v[60:61], v[76:77] op_sel:[1,1,0] op_sel_hi:[1,0,1] neg_lo:[0,1,0]
    v_pk_mul_f32 v[74:75], v[72:73], v[68:69] op_sel_hi:[0,1]
    v_pk_mul_f32 v[78:79], v[76:77], v[60:61] op_sel_hi:[0,1]
    v_pk_fma_f32 v[74:75], v[72:73], v[68:69], v[74:75] op_sel:[1,1,0] op_sel_hi:[1,0,1] neg_lo:[0,1,0]
    v_pk_fma_f32 v[78:79], v[76:77], v[60:61], v[78:79] op_sel:[1,1,0] op_sel_hi:[1,0,1] neg_lo:[0,1,0]
    v_cvt_pk_bf16_f32 v109, v72, v74
    v_cvt_pk_bf16_f32 v125, v76, v78
    v_cvt_pk_bf16_f32 v117, -v73, -v75
    v_cvt_pk_bf16_f32 v133, v77, v79
    ds_write_b128 v50, v[120:123] offset:0
    v_pk_mul_f32 v[72:73], v[74:75], v[68:69] op_sel_hi:[0,1]
    v_pk_mul_f32 v[76:77], v[78:79], v[60:61] op_sel_hi:[0,1]
    v_pk_fma_f32 v[72:73], v[74:75], v[68:69], v[72:73] op_sel:[1,1,0] op_sel_hi:[1,0,1] neg_lo:[0,1,0]
    v_pk_fma_f32 v[76:77], v[78:79], v[60:61], v[76:77] op_sel:[1,1,0] op_sel_hi:[1,0,1] neg_lo:[0,1,0]
    v_pk_mul_f32 v[74:75], v[72:73], v[68:69] op_sel_hi:[0,1]
    v_pk_mul_f32 v[78:79], v[76:77], v[60:61] op_sel_hi:[0,1]
    v_pk_fma_f32 v[74:75], v[72:73], v[68:69], v[74:75] op_sel:[1,1,0] op_sel_hi:[1,0,1] neg_lo:[0,1,0]
    v_pk_fma_f32 v[78:79], v[76:77], v[60:61], v[78:79] op_sel:[1,1,0] op_sel_hi:[1,0,1] neg_lo:[0,1,0]
    v_cvt_pk_bf16_f32 v110, v72, v74
    v_cvt_pk_bf16_f32 v126, v76, v78
    v_cvt_pk_bf16_f32 v118, -v73, -v75
    v_cvt_pk_bf16_f32 v134, v77, v79
    ds_write_b128 v50, v[128:131] offset:2080
    v_pk_mul_f32 v[72:73], v[74:75], v[68:69] op_sel_hi:[0,1]
    v_pk_mul_f32 v[76:77], v[78:79], v[60:61] op_sel_hi:[0,1]
    v_pk_fma_f32 v[72:73], v[74:75], v[68:69], v[72:73] op_sel:[1,1,0] op_sel_hi:[1,0,1] neg_lo:[0,1,0]
    v_pk_fma_f32 v[76:77], v[78:79], v[60:61], v[76:77] op_sel:[1,1,0] op_sel_hi:[1,0,1] neg_lo:[0,1,0]
    v_pk_mul_f32 v[74:75], v[72:73], v[68:69] op_sel_hi:[0,1]
    v_pk_mul_f32 v[78:79], v[76:77], v[60:61] op_sel_hi:[0,1]
    v_pk_fma_f32 v[74:75], v[72:73], v[68:69], v[74:75] op_sel:[1,1,0] op_sel_hi:[1,0,1] neg_lo:[0,1,0]
    v_pk_fma_f32 v[78:79], v[76:77], v[60:61], v[78:79] op_sel:[1,1,0] op_sel_hi:[1,0,1] neg_lo:[0,1,0]
    v_cvt_pk_bf16_f32 v111, v72, v74
    v_cvt_pk_bf16_f32 v127, v76, v78
    v_cvt_pk_bf16_f32 v119, -v73, -v75
    v_cvt_pk_bf16_f32 v135, v77, v79
    ds_write_b128 v40, v[108:111] offset:1088
    v_pk_mul_f32 v[74:75], v[70:71], v[62:63] op_sel_hi:[0,1]
    v_pk_mul_f32 v[80:81], v[70:71], v[70:71] op_sel_hi:[0,1]
    v_pk_fma_f32 v[74:75], v[70:71], v[62:63], v[74:75] op_sel:[1,1,0] op_sel_hi:[1,0,1] neg_lo:[0,1,0]
    ds_write_b128 v40, v[116:119] offset:3264
    v_pk_fma_f32 v[80:81], v[70:71], v[70:71], v[80:81] op_sel:[1,1,0] op_sel_hi:[1,0,1] neg_lo:[0,1,0]
    v_cvt_pk_bf16_f32 v136, v70, v74
    ds_write_b128 v50, v[124:127] offset:1040
    v_pk_mul_f32 v[78:79], v[80:81], v[64:65] op_sel_hi:[0,1]
    v_cvt_pk_bf16_f32 v144, v71, v75
    ds_write_b128 v50, v[132:135] offset:3120
    v_pk_fma_f32 v[78:79], v[80:81], v[64:65], v[78:79] op_sel:[1,1,0] op_sel_hi:[1,0,1] neg_lo:[0,1,0]
    v_pk_mul_f32 v[72:73], v[74:75], v[62:63] op_sel_hi:[0,1]
    v_cvt_pk_bf16_f32 v140, v80, v78
    ds_read_b64_tr_b16 v[168:169], v41 offset:0
    v_pk_fma_f32 v[72:73], v[74:75], v[62:63], v[72:73] op_sel:[1,1,0] op_sel_hi:[1,0,1] neg_lo:[0,1,0]
    v_cvt_pk_bf16_f32 v148, v81, v79
    ds_read_b64_tr_b16 v[170:171], v41 offset:64
    v_pk_mul_f32 v[74:75], v[72:73], v[62:63] op_sel_hi:[0,1]
    v_pk_mul_f32 v[76:77], v[78:79], v[64:65] op_sel_hi:[0,1]
    ds_read_b64_tr_b16 v[172:173], v41 offset:512
    v_pk_fma_f32 v[74:75], v[72:73], v[62:63], v[74:75] op_sel:[1,1,0] op_sel_hi:[1,0,1] neg_lo:[0,1,0]
    v_pk_fma_f32 v[76:77], v[78:79], v[64:65], v[76:77] op_sel:[1,1,0] op_sel_hi:[1,0,1] neg_lo:[0,1,0]
    v_cvt_pk_bf16_f32 v137, v72, v74
    ds_read_b64_tr_b16 v[174:175], v41 offset:576
    v_pk_mul_f32 v[78:79], v[76:77], v[64:65] op_sel_hi:[0,1]
    v_cvt_pk_bf16_f32 v145, v73, v75
    ds_read_b64_tr_b16 v[176:177], v41 offset:2176
    v_pk_fma_f32 v[78:79], v[76:77], v[64:65], v[78:79] op_sel:[1,1,0] op_sel_hi:[1,0,1] neg_lo:[0,1,0]
    v_pk_mul_f32 v[72:73], v[74:75], v[62:63] op_sel_hi:[0,1]
    ds_read_b64_tr_b16 v[178:179], v41 offset:2240
    v_cvt_pk_bf16_f32 v141, v76, v78
    v_pk_fma_f32 v[72:73], v[74:75], v[62:63], v[72:73] op_sel:[1,1,0] op_sel_hi:[1,0,1] neg_lo:[0,1,0]
    ds_read_b64_tr_b16 v[180:181], v41 offset:2688
    v_cvt_pk_bf16_f32 v149, v77, v79
    v_pk_mul_f32 v[74:75], v[72:73], v[62:63] op_sel_hi:[0,1]
    v_pk_mul_f32 v[82:83], v[80:81], v[70:71] op_sel_hi:[0,1]
    ds_read_b64_tr_b16 v[182:183], v41 offset:2752
    v_pk_fma_f32 v[74:75], v[72:73], v[62:63], v[74:75] op_sel:[1,1,0] op_sel_hi:[1,0,1] neg_lo:[0,1,0]
    v_pk_fma_f32 v[82:83], v[80:81], v[70:71], v[82:83] op_sel:[1,1,0] op_sel_hi:[1,0,1] neg_lo:[0,1,0]
    ds_read_b64_tr_b16 v[184:185], v51 offset:0
    v_cvt_pk_bf16_f32 v138, v72, v74
    v_pk_mul_f32 v[78:79], v[82:83], v[64:65] op_sel_hi:[0,1]
    ds_read_b64_tr_b16 v[186:187], v51 offset:64
    v_cvt_pk_bf16_f32 v146, v73, v75
    v_pk_fma_f32 v[78:79], v[82:83], v[64:65], v[78:79] op_sel:[1,1,0] op_sel_hi:[1,0,1] neg_lo:[0,1,0]
    v_pk_mul_f32 v[72:73], v[74:75], v[62:63] op_sel_hi:[0,1]
    ds_read_b64_tr_b16 v[188:189], v51 offset:512
    v_cvt_pk_bf16_f32 v142, v82, v78
    v_pk_fma_f32 v[72:73], v[74:75], v[62:63], v[72:73] op_sel:[1,1,0] op_sel_hi:[1,0,1] neg_lo:[0,1,0]
    ds_read_b64_tr_b16 v[190:191], v51 offset:576
    v_cvt_pk_bf16_f32 v150, v83, v79
    v_pk_mul_f32 v[74:75], v[72:73], v[62:63] op_sel_hi:[0,1]
    ds_read_b64_tr_b16 v[192:193], v51 offset:2080
    v_pk_mul_f32 v[76:77], v[78:79], v[64:65] op_sel_hi:[0,1]
    v_pk_fma_f32 v[74:75], v[72:73], v[62:63], v[74:75] op_sel:[1,1,0] op_sel_hi:[1,0,1] neg_lo:[0,1,0]
    v_pk_fma_f32 v[76:77], v[78:79], v[64:65], v[76:77] op_sel:[1,1,0] op_sel_hi:[1,0,1] neg_lo:[0,1,0]
    ds_read_b64_tr_b16 v[194:195], v51 offset:2144
    v_cvt_pk_bf16_f32 v139, v72, v74
    v_pk_mul_f32 v[78:79], v[76:77], v[64:65] op_sel_hi:[0,1]
    ds_read_b64_tr_b16 v[196:197], v51 offset:2592
    v_cvt_pk_bf16_f32 v147, v73, v75
    v_pk_fma_f32 v[78:79], v[76:77], v[64:65], v[78:79] op_sel:[1,1,0] op_sel_hi:[1,0,1] neg_lo:[0,1,0]
    ds_read_b64_tr_b16 v[198:199], v51 offset:2656
    v_cvt_pk_bf16_f32 v143, v76, v78
    v_cvt_pk_bf16_f32 v151, v77, v79
    ds_write_b128 v40, v[136:139] offset:0
    v_pk_mul_f32 v[80:81], v[82:83], v[70:71] op_sel_hi:[0,1]
    v_pk_fma_f32 v[80:81], v[82:83], v[70:71], v[80:81] op_sel:[1,1,0] op_sel_hi:[1,0,1] neg_lo:[0,1,0]
    v_pk_mul_f32 v[78:79], v[80:81], v[66:67] op_sel_hi:[0,1]
    ds_write_b128 v40, v[144:147] offset:2176
    v_pk_fma_f32 v[78:79], v[80:81], v[66:67], v[78:79] op_sel:[1,1,0] op_sel_hi:[1,0,1] neg_lo:[0,1,0]
    v_cvt_pk_bf16_f32 v152, v80, v78
    ds_write_b128 v40, v[140:143] offset:1088
    v_cvt_pk_bf16_f32 v160, v81, v79
    v_pk_mul_f32 v[82:83], v[80:81], v[70:71] op_sel_hi:[0,1]
    ds_write_b128 v40, v[148:151] offset:3264
    v_pk_fma_f32 v[82:83], v[80:81], v[70:71], v[82:83] op_sel:[1,1,0] op_sel_hi:[1,0,1] neg_lo:[0,1,0]
    v_pk_mul_f32 v[78:79], v[82:83], v[66:67] op_sel_hi:[0,1]
    v_pk_fma_f32 v[78:79], v[82:83], v[66:67], v[78:79] op_sel:[1,1,0] op_sel_hi:[1,0,1] neg_lo:[0,1,0]
    ds_read_b64_tr_b16 v[200:201], v41 offset:0
    v_cvt_pk_bf16_f32 v153, v82, v78
    v_cvt_pk_bf16_f32 v161, v83, v79
    ds_read_b64_tr_b16 v[202:203], v41 offset:64
    v_pk_mul_f32 v[80:81], v[82:83], v[70:71] op_sel_hi:[0,1]
    v_pk_fma_f32 v[80:81], v[82:83], v[70:71], v[80:81] op_sel:[1,1,0] op_sel_hi:[1,0,1] neg_lo:[0,1,0]
    ds_read_b64_tr_b16 v[204:205], v41 offset:512
    v_pk_mul_f32 v[78:79], v[80:81], v[66:67] op_sel_hi:[0,1]
    v_pk_fma_f32 v[78:79], v[80:81], v[66:67], v[78:79] op_sel:[1,1,0] op_sel_hi:[1,0,1] neg_lo:[0,1,0]
    v_cvt_pk_bf16_f32 v154, v80, v78
    ds_read_b64_tr_b16 v[206:207], v41 offset:576
    v_cvt_pk_bf16_f32 v162, v81, v79
    v_pk_mul_f32 v[82:83], v[80:81], v[70:71] op_sel_hi:[0,1]
    ds_read_b64_tr_b16 v[208:209], v41 offset:2176
    v_pk_fma_f32 v[82:83], v[80:81], v[70:71], v[82:83] op_sel:[1,1,0] op_sel_hi:[1,0,1] neg_lo:[0,1,0]
    v_pk_mul_f32 v[78:79], v[82:83], v[66:67] op_sel_hi:[0,1]
    ds_read_b64_tr_b16 v[210:211], v41 offset:2240
    v_pk_fma_f32 v[78:79], v[82:83], v[66:67], v[78:79] op_sel:[1,1,0] op_sel_hi:[1,0,1] neg_lo:[0,1,0]
    v_cvt_pk_bf16_f32 v155, v82, v78
    v_cvt_pk_bf16_f32 v163, v83, v79
    ds_read_b64_tr_b16 v[212:213], v41 offset:2688
    v_pk_mul_f32 v[80:81], v[82:83], v[70:71] op_sel_hi:[0,1]
    v_pk_fma_f32 v[80:81], v[82:83], v[70:71], v[80:81] op_sel:[1,1,0] op_sel_hi:[1,0,1] neg_lo:[0,1,0]
    ds_read_b64_tr_b16 v[214:215], v41 offset:2752
    v_cvt_pk_bf16_f32 v156, v80, v80
    v_cvt_pk_bf16_f32 v164, v81, v81
    ds_write_b128 v50, v[152:155] offset:0
    ds_write_b128 v50, v[160:163] offset:2080
    ds_write_b32 v50, v156 offset:1040
    ds_write_b32 v50, v164 offset:3120
    ds_read_b64_tr_b16 v[216:217], v51 offset:0
    ds_read_b64_tr_b16 v[218:219], v51 offset:64
    ds_read_b64_tr_b16 v[220:221], v51 offset:512
    ds_read_b64_tr_b16 v[222:223], v51 offset:576
    ds_read_b64_tr_b16 v[224:225], v51 offset:2080
    ds_read_b64_tr_b16 v[226:227], v51 offset:2144
    ds_read_b64_tr_b16 v[228:229], v51 offset:2592
    ds_read_b64_tr_b16 v[230:231], v51 offset:2656
    s_waitcnt lgkmcnt(12)
    v_mfma_f32_16x16x32_bf16 v[84:87], v[184:187], v[168:171], 0
    v_mfma_f32_16x16x32_bf16 v[84:87], v[188:191], v[172:175], v[84:87]
    v_mfma_f32_16x16x32_bf16 v[84:87], v[192:195], v[176:179], v[84:87]
    v_mfma_f32_16x16x32_bf16 v[84:87], v[196:199], v[180:183], v[84:87]
    v_mfma_f32_16x16x32_bf16 v[88:91], v[200:203], v[168:171], 0
    v_mfma_f32_16x16x32_bf16 v[88:91], v[204:207], v[172:175], v[88:91]
    v_mfma_f32_16x16x32_bf16 v[88:91], v[208:211], v[176:179], v[88:91]
    v_mfma_f32_16x16x32_bf16 v[88:91], v[212:215], v[180:183], v[88:91]
    s_mov_b64 exec, 0xff
    ds_write_b128 v50, v[96:99]
    s_mov_b64 exec, -1
    s_nop 0
    ds_write_b128 v42, v[84:87]
    s_nop 2
    ds_write_b128 v43, v[88:91] offset:1024
    s_waitcnt lgkmcnt(3)
    v_mfma_f32_16x16x32_bf16 v[92:95], v[216:219], v[168:171], 0
    v_mfma_f32_16x16x32_bf16 v[92:95], v[220:223], v[172:175], v[92:95]
    v_mfma_f32_16x16x32_bf16 v[92:95], v[224:227], v[176:179], v[92:95]
    v_mfma_f32_16x16x32_bf16 v[92:95], v[228:231], v[180:183], v[92:95]
    s_nop 7
    ds_write_b64 v44, v[92:93] offset:2048
    ds_write_b64 v44, v[94:95] offset:2176
    s_waitcnt lgkmcnt(0)
    s_barrier
    s_bitcmp1_b32 s28, 0
    s_cbranch_scc1 CK_exp1
    ds_read_b128 v[104:107], v45 offset:0
    ds_read_b64 v[108:109], v46 offset:1024
    ds_read_b32 v110, v46 offset:1032
    ds_read_b32 v112, v47 offset:1536
    ds_read_b32 v113, v47 offset:1540
    ds_read_b32 v114, v47 offset:1792
    ds_read_b32 v115, v47 offset:1796
    ds_read_b128 v[120:123], v45 offset:4352
    ds_read_b64 v[124:125], v46 offset:5376
    ds_read_b32 v126, v46 offset:5384
    ds_read_b32 v128, v47 offset:5888
    ds_read_b32 v129, v47 offset:5892
    ds_read_b32 v130, v47 offset:6144
    ds_read_b32 v131, v47 offset:6148
    s_waitcnt lgkmcnt(0)
    v_add_f32 v104, v104, v120
    v_add_f32 v105, v105, v121
    v_add_f32 v106, v106, v122
    v_add_f32 v107, v107, v123
    v_add_f32 v108, v108, v124
    v_add_f32 v109, v109, v125
    v_add_f32 v110, v110, v126
    v_add_f32 v112, v112, v128
    v_add_f32 v113, v113, v129
    v_add_f32 v114, v114, v130
    v_add_f32 v115, v115, v131
    s_mov_b64 exec, 1
    v_add_f32 v104, v104, v52
    s_mov_b64 exec, -1
    v_cndmask_b32 v116, v113, v112, vcc
    v_cndmask_b32 v117, v115, v114, vcc
    v_cvt_pk_bf16_f32 v54, v104, v105
    v_cvt_pk_bf16_f32 v55, v106, v107
    ds_write_b64 v48, v[54:55] offset:0
    ds_write_b32 v49, v54 offset:0
    ds_write_b32 v49, v55 offset:4
    v_cvt_pk_bf16_f32 v100, v108, v108
    v_cvt_pk_bf16_f32 v101, v109, v110
    ds_write_b64 v48, v[100:101] offset:512
    ds_write_b32 v49, v100 offset:512
    ds_write_b32 v49, v101 offset:516
    v_cvt_pk_bf16_f32 v54, v112, v112
    v_cvt_pk_bf16_f32 v55, v116, v113
    ds_write_b64 v48, v[54:55] offset:1024
    ds_write_b32 v49, v54 offset:1024
    ds_write_b32 v49, v55 offset:1028
    v_cvt_pk_bf16_f32 v100, v114, v114
    v_cvt_pk_bf16_f32 v101, v117, v115
    ds_write_b64 v48, v[100:101] offset:1536
    ds_write_b32 v49, v100 offset:1536
    ds_write_b32 v49, v101 offset:1540
    s_branch CK_expd
CK_exp1:
    ds_read_b32 v104, v45 offset:2048
    ds_read_b32 v108, v46 offset:2048
    ds_read_b32 v105, v45 offset:2176
    ds_read_b32 v109, v46 offset:2176
    ds_read_b32 v106, v45 offset:2304
    ds_read_b32 v110, v46 offset:2304
    ds_read_b32 v107, v45 offset:2432
    ds_read_b32 v111, v46 offset:2432
    ds_read_b32 v112, v45 offset:6400
    ds_read_b32 v116, v46 offset:6400
    ds_read_b32 v113, v45 offset:6528
    ds_read_b32 v117, v46 offset:6528
    ds_read_b32 v114, v45 offset:6656
    ds_read_b32 v118, v46 offset:6656
    ds_read_b32 v115, v45 offset:6784
    ds_read_b32 v119, v46 offset:6784
    s_waitcnt lgkmcnt(0)
    v_add_f32 v104, v104, v112
    v_add_f32 v105, v105, v113
    v_add_f32 v106, v106, v114
    v_add_f32 v107, v107, v115
    v_add_f32 v108, v108, v116
    v_add_f32 v109, v109, v117
    v_add_f32 v110, v110, v118
    v_add_f32 v111, v111, v119
    v_cvt_pk_bf16_f32 v54, v104, v108
    v_cvt_pk_bf16_f32 v55, v108, v108
    ds_write_b64 v48, v[54:55] offset:2048
    ds_write_b32 v49, v54 offset:2048
    ds_write_b32 v49, v55 offset:2052
    v_cvt_pk_bf16_f32 v100, v105, v109
    v_cvt_pk_bf16_f32 v101, v109, v109
    ds_write_b64 v48, v[100:101] offset:2560
    ds_write_b32 v49, v100 offset:2560
    ds_write_b32 v49, v101 offset:2564
    v_cvt_pk_bf16_f32 v54, v106, v110
    v_cvt_pk_bf16_f32 v55, v110, v110
    ds_write_b64 v48, v[54:55] offset:3072
    ds_write_b32 v49, v54 offset:3072
    ds_write_b32 v49, v55 offset:3076
    v_cvt_pk_bf16_f32 v100, v107, v111
    v_cvt_pk_bf16_f32 v101, v111, v111
    ds_write_b64 v48, v[100:101] offset:3584
    ds_write_b32 v49, v100 offset:3584
    ds_write_b32 v49, v101 offset:3588
CK_expd:
    s_mov_b32 s69, 81920
    s_cmp_lg_u32 s31, 0
    s_cbranch_scc1 C_aux
    s_barrier
    ds_read_b128 v[76:79], v13
    ds_read_b64_tr_b16 v[84:85], v18 offset:0
    ds_read_b64_tr_b16 v[86:87], v18 offset:1024
    ds_read_b64_tr_b16 v[88:89], v18 offset:8192
    ds_read_b64_tr_b16 v[90:91], v18 offset:9216
    ds_read_b64_tr_b16 v[92:93], v19 offset:0
    ds_read_b64_tr_b16 v[94:95], v19 offset:1024
    ds_read_b64_tr_b16 v[96:97], v19 offset:8192
    ds_read_b64_tr_b16 v[98:99], v19 offset:9216
    ds_read_b128 v[80:83], v13 offset:4096
    s_waitcnt lgkmcnt(0)
    v_mfma_f32_32x32x16_bf16 v[124:139], v[84:87], v[76:79], 0
    ds_read_b128 v[100:103], v14
    ds_read_b64_tr_b16 v[108:109], v18 offset:4096
    v_bfe_u32 v2, v1, 2, 2
    v_lshrrev_b32 v3, 5, v1
    v_lshl_add_u32 v3, v3, 2, v2
    v_lshlrev_b32 v3, 7, v3
    v_mfma_f32_32x32x16_bf16 v[140:155], v[88:91], v[76:79], 0
    ds_read_b64_tr_b16 v[110:111], v18 offset:5120
    ds_read_b64_tr_b16 v[112:113], v18 offset:12288
    v_lshrrev_b32 v2, 1, v2
    s_lshr_b32 s34, s28, 1
    v_xor_b32 v2, s34, v2
    v_lshl_add_u32 v3, v2, 6, v3
    v_mfma_f32_32x32x16_bf16 v[156:171], v[92:95], v[76:79], 0
    ds_read_b64_tr_b16 v[114:115], v18 offset:13312
    ds_read_b64_tr_b16 v[116:117], v19 offset:4096
    v_bfe_u32 v2, v1, 4, 1
    v_lshl_add_u32 v3, v2, 5, v3
    v_and_b32 v2, 3, v1
    v_lshl_add_u32 v3, v2, 3, v3
    v_mfma_f32_32x32x16_bf16 v[172:187], v[96:99], v[76:79], 0
    ds_read_b64_tr_b16 v[118:119], v19 offset:5120
    ds_read_b64_tr_b16 v[120:121], v19 offset:12288
    s_lshl_b32 s72, s28, 11
    v_add_u32 v20, s72, v3
    v_xor_b32 v21, 64, v20
    v_add_u32 v22, 0x10000, v20
    v_mfma_f32_32x32x16_bf16 v[188:203], v[84:87], v[80:83], 0
    ds_read_b64_tr_b16 v[122:123], v19 offset:13312
    ds_read_b128 v[104:107], v14 offset:4096
    v_add_u32 v23, 0x10000, v21
    s_and_b32 s34, s28, 1
    s_mul_i32 s34, s34, 114688
    v_add_u32 v26, s34, v17
    v_mfma_f32_32x32x16_bf16 v[204:219], v[88:91], v[80:83], 0
    s_sub_u32 s34, 114688, s34
    v_add_u32 v27, s34, v17
    v_bfe_u32 v2, v1, 4, 1
    v_lshlrev_b32 v2, 2, v2
    v_xor_b32 v2, v2, v1
    v_and_b32 v2, 7, v2
    v_lshlrev_b32 v2, 4, v2
    v_lshrrev_b32 v24, 3, v1
    v_mfma_f32_32x32x16_bf16 v[220:235], v[92:95], v[80:83], 0
    v_lshl_add_u32 v24, v24, 10, v2
    s_mul_i32 s34, s28, 458752
    s_lshl_b32 s35, s33, 7
    s_add_u32 s34, s34, s35
    s_and_b32 s35, s32, 3
    s_lshl_b32 s35, s35, 1
    s_add_u32 s35, s35, s33
    s_cmp_ge_u32 s35, 7
    s_cselect_b32 s80, 7, 0
    v_mfma_f32_32x32x16_bf16 v[236:251], v[96:99], v[80:83], 0
    s_waitcnt lgkmcnt(0)
    v_mfma_f32_32x32x16_bf16 v[124:139], v[108:111], v[100:103], v[124:139]
    s_barrier
    ds_read_b128 v[76:79], v15
    ds_read_b64_tr_b16 v[84:85], v18 offset:16384
    s_sub_u32 s35, s35, s80
    s_lshl_b32 s35, s35, 12
    s_mul_i32 s78, s32, 229376
    s_mul_i32 s79, s28, 28672
    v_mfma_f32_32x32x16_bf16 v[140:155], v[112:115], v[100:103], v[140:155]
    ds_read_b64_tr_b16 v[86:87], v18 offset:17408
    ds_read_b64_tr_b16 v[88:89], v18 offset:24576
    s_add_u32 s78, s78, s79
    s_lshl_b32 s80, s35, 4
    s_add_u32 s80, s80, s34
    s_add_u32 s87, s78, s35
    v_mfma_f32_32x32x16_bf16 v[156:171], v[116:119], v[100:103], v[156:171]
    ds_read_b64_tr_b16 v[90:91], v18 offset:25600
    ds_read_b64_tr_b16 v[92:93], v19 offset:16384
    s_add_u32 s35, s35, 4096
    s_cmp_eq_u32 s35, 28672
    s_cselect_b32 s35, 0, s35
    s_lshl_b32 s81, s35, 4
    s_add_u32 s81, s81, s34
    v_mfma_f32_32x32x16_bf16 v[172:187], v[120:123], v[100:103], v[172:187]
    ds_read_b64_tr_b16 v[94:95], v19 offset:17408
    ds_read_b64_tr_b16 v[96:97], v19 offset:24576
    s_add_u32 s88, s78, s35
    s_add_u32 s35, s35, 4096
    s_cmp_eq_u32 s35, 28672
    s_cselect_b32 s35, 0, s35
    s_lshl_b32 s82, s35, 4
    v_mfma_f32_32x32x16_bf16 v[188:203], v[108:111], v[104:107], v[188:203]
    ds_read_b64_tr_b16 v[98:99], v19 offset:25600
    ds_read_b128 v[80:83], v15 offset:4096
    s_add_u32 s82, s82, s34
    s_add_u32 s89, s78, s35
    s_add_u32 s35, s35, 4096
    s_cmp_eq_u32 s35, 28672
    s_cselect_b32 s35, 0, s35
    v_mfma_f32_32x32x16_bf16 v[204:219], v[112:115], v[104:107], v[204:219]
    s_lshl_b32 s83, s35, 4
    s_add_u32 s83, s83, s34
    s_add_u32 s90, s78, s35
    s_add_u32 s35, s35, 4096
    s_cmp_eq_u32 s35, 28672
    s_cselect_b32 s35, 0, s35
    s_lshl_b32 s84, s35, 4
    s_add_u32 s84, s84, s34
    s_add_u32 s91, s78, s35
    v_mfma_f32_32x32x16_bf16 v[220:235], v[116:119], v[104:107], v[220:235]
    s_add_u32 s35, s35, 4096
    s_cmp_eq_u32 s35, 28672
    s_cselect_b32 s35, 0, s35
    s_lshl_b32 s85, s35, 4
    s_add_u32 s85, s85, s34
    s_add_u32 s92, s78, s35
    s_add_u32 s35, s35, 4096
    s_cmp_eq_u32 s35, 28672
    s_cselect_b32 s35, 0, s35
    s_lshl_b32 s86, s35, 4
    v_mfma_f32_32x32x16_bf16 v[236:251], v[120:123], v[104:107], v[236:251]
    s_waitcnt lgkmcnt(0)
    v_mfma_f32_32x32x16_bf16 v[124:139], v[84:87], v[76:79], v[124:139]
    ds_read_b128 v[100:103], v16
    ds_read_b64_tr_b16 v[108:109], v18 offset:20480
    s_add_u32 s86, s86, s34
    s_add_u32 s93, s78, s35
    s_mov_b32 s20, s60
    s_mov_b32 s21, s61
    v_mfma_f32_32x32x16_bf16 v[140:155], v[88:91], v[76:79], v[140:155]
    ds_read_b64_tr_b16 v[110:111], v18 offset:21504
    ds_read_b64_tr_b16 v[112:113], v18 offset:28672
    s_mov_b32 s22, 1835008
    s_mov_b32 s23, 0x20000
    s_mov_b32 s24, s64
    s_mov_b32 s25, s65
    v_mfma_f32_32x32x16_bf16 v[156:171], v[92:95], v[76:79], v[156:171]
    ds_read_b64_tr_b16 v[114:115], v18 offset:29696
    ds_read_b64_tr_b16 v[116:117], v19 offset:20480
    s_mov_b32 s26, 2097152
    s_mov_b32 s27, 0x20000
    s_mul_i32 s95, s32, 28
    s_mul_i32 s34, s28, 7
    v_mfma_f32_32x32x16_bf16 v[172:187], v[96:99], v[76:79], v[172:187]
    ds_read_b64_tr_b16 v[118:119], v19 offset:21504
    ds_read_b64_tr_b16 v[120:121], v19 offset:28672
    s_add_u32 s95, s95, s34
    s_lshl_b32 s95, s95, 7
    s_add_u32 s95, s95, 15728640
    s_and_b32 s34, s28, 1
    v_mfma_f32_32x32x16_bf16 v[188:203], v[84:87], v[80:83], v[188:203]
    ds_read_b64_tr_b16 v[122:123], v19 offset:29696
    ds_read_b128 v[104:107], v16 offset:4096
    s_lshl_b32 s34, s34, 5
    s_lshl_b32 s35, s32, 6
    s_add_u32 s34, s34, s35
    v_and_b32 v2, 31, v1
    v_mfma_f32_32x32x16_bf16 v[204:219], v[88:91], v[80:83], v[204:219]
    v_add_u32 v2, s34, v2
    v_lshrrev_b32 v3, 5, v1
    s_lshr_b32 s34, s28, 1
    s_lshl_b32 s34, s34, 6
    s_lshl_b32 s35, s33, 7
    s_add_u32 s34, s34, s35
    v_lshlrev_b32 v4, 3, v3
    v_add_u32 v4, s34, v4
    v_mfma_f32_32x32x16_bf16 v[220:235], v[92:95], v[80:83], v[220:235]
    v_lshl_add_u32 v253, v2, 10, v4
    v_lshlrev_b32 v255, 3, v2
    v_lshrrev_b32 v3, 8, v2
    v_lshlrev_b32 v254, 11, v3
    v_bfe_u32 v3, v2, 1, 1
    v_lshl_add_u32 v254, v3, 10, v254
    v_bfe_u32 v3, v2, 2, 6
    v_lshl_add_u32 v254, v3, 4, v254
    v_mfma_f32_32x32x16_bf16 v[236:251], v[96:99], v[80:83], v[236:251]
    s_waitcnt lgkmcnt(0)
    v_mfma_f32_32x32x16_bf16 v[124:139], v[108:111], v[100:103], v[124:139]
    s_add_u32 s69, s69, 16384
    s_cmp_eq_u32 s69, 114688
    s_cselect_b32 s69, 65536, s69
    v_xor_b32 v18, 0x8000, v18
    v_xor_b32 v19, 0x8000, v19
    v_add_u32 v13, s69, v9
    s_barrier
    ds_read_b128 v[76:79], v13
    ds_read_b64_tr_b16 v[84:85], v18 offset:0
    v_and_b32 v3, 1, v2
    v_lshl_add_u32 v254, v3, 3, v254
    v_lshl_add_u32 v254, v4, 12, v254
    s_and_b32 s34, s28, 1
    v_mfma_f32_32x32x16_bf16 v[140:155], v[112:115], v[100:103], v[140:155]
    ds_read_b64_tr_b16 v[86:87], v18 offset:1024
    ds_read_b64_tr_b16 v[88:89], v18 offset:8192
    s_lshl_b32 s34, s34, 1
    s_lshl_b32 s35, s29, 2
    s_add_u32 s34, s34, s35
    s_mul_i32 s34, s34, 112
    v_mfma_f32_32x32x16_bf16 v[156:171], v[116:119], v[100:103], v[156:171]
    ds_read_b64_tr_b16 v[90:91], v18 offset:9216
    ds_read_b64_tr_b16 v[92:93], v19 offset:0
    s_lshl_b32 s35, s30, 3
    s_add_u32 s34, s34, s35
    s_and_b32 s35, s28, 2
    s_lshl_b32 s35, s35, 1
    v_mfma_f32_32x32x16_bf16 v[172:187], v[120:123], v[100:103], v[172:187]
    ds_read_b64_tr_b16 v[94:95], v19 offset:1024
    ds_read_b64_tr_b16 v[96:97], v19 offset:8192
    s_add_u32 s34, s34, s35
    s_lshl_b32 s73, s34, 10
    s_add_u32 s74, s73, 114688
    s_lshr_b32 s71, s28, 1
    v_mfma_f32_32x32x16_bf16 v[188:203], v[108:111], v[104:107], v[188:203]
    ds_read_b64_tr_b16 v[98:99], v19 offset:9216
    ds_read_b128 v[80:83], v13 offset:4096
    s_lshl_b32 s35, s30, 1
    s_add_u32 s71, s71, s35
    s_and_b32 s34, s28, 1
    s_lshl_b32 s35, s29, 1
    v_mfma_f32_32x32x16_bf16 v[204:219], v[112:115], v[104:107], v[204:219]
    s_add_u32 s34, s34, s35
    s_mul_i32 s34, s34, 28
    s_add_u32 s71, s71, s34
    s_lshl_b32 s71, s71, 7
    s_add_u32 s71, s71, 15728640
    s_mov_b32 s78, 3216550459
    s_mov_b32 s79, 3216550459
    s_add_u32 s34, s2, s28
    v_mfma_f32_32x32x16_bf16 v[220:235], v[116:119], v[104:107], v[220:235]
    s_add_u32 s34, s34, 0
    s_and_b32 s34, s34, 7
    s_mul_i32 s34, s34, 28
    s_lshr_b32 s96, s2, 3
    s_add_u32 s96, s96, s34
    s_and_b32 s34, s28, 0
    s_xor_b32 s96, s96, s34
    s_lshl_b32 s96, s96, 13
    v_mfma_f32_32x32x16_bf16 v[236:251], v[120:123], v[104:107], v[236:251]
    v_add_u32 v14, s69, v10
    v_add_u32 v15, s69, v11
    v_add_u32 v16, s69, v12
    s_mov_b64 exec, 0x7f
    buffer_load_dword v60, v252, s[16:19], s95 offen sc1
    s_mov_b64 exec, -1
    global_load_dword v5, v25, s[66:67] sc1
C_loop:
    s_waitcnt lgkmcnt(0)
    v_mfma_f32_32x32x16_bf16 v[124:139], v[84:87], v[76:79], v[124:139]
    ds_read_b128 v[100:103], v14
    ds_read_b64_tr_b16 v[108:109], v18 offset:4096
    v_mfma_f32_32x32x16_bf16 v[140:155], v[88:91], v[76:79], v[140:155]
    ds_read_b64_tr_b16 v[110:111], v18 offset:5120
    ds_read_b64_tr_b16 v[112:113], v18 offset:12288
    v_mfma_f32_32x32x16_bf16 v[156:171], v[92:95], v[76:79], v[156:171]
    ds_read_b64_tr_b16 v[114:115], v18 offset:13312
    ds_read_b64_tr_b16 v[116:117], v19 offset:4096
    v_mfma_f32_32x32x16_bf16 v[172:187], v[96:99], v[76:79], v[172:187]
    ds_read_b64_tr_b16 v[118:119], v19 offset:5120
    ds_read_b64_tr_b16 v[120:121], v19 offset:12288
    v_mfma_f32_32x32x16_bf16 v[188:203], v[84:87], v[80:83], v[188:203]
    ds_read_b64_tr_b16 v[122:123], v19 offset:13312
    ds_read_b128 v[104:107], v14 offset:4096
    v_mfma_f32_32x32x16_bf16 v[204:219], v[88:91], v[80:83], v[204:219]
    s_lshl_b32 s34, s70, 1
    s_add_u32 s34, s34, -3
    s_sub_u32 s34, s34, s28
    s_and_b32 s34, s34, 0xfffffffb
    s_cbranch_scc1 Lpf7
    buffer_load_dword v60, v252, s[20:23], s96 offen
    s_mov_b64 exec, -1
    s_add_u32 s96, s96, 917504
    s_cmp_ge_u32 s96, 1835008
    s_cselect_b32 s34, 1835008, 0
    s_sub_u32 s96, s96, s34
Lpf7:
    v_mfma_f32_32x32x16_bf16 v[220:235], v[92:95], v[80:83], v[220:235]
    v_mfma_f32_32x32x16_bf16 v[236:251], v[96:99], v[80:83], v[236:251]
    s_waitcnt lgkmcnt(0)
    v_mfma_f32_32x32x16_bf16 v[124:139], v[108:111], v[100:103], v[124:139]
    s_barrier
    ds_read_b128 v[76:79], v15
    ds_read_b64_tr_b16 v[84:85], v18 offset:16384
    v_mfma_f32_32x32x16_bf16 v[140:155], v[112:115], v[100:103], v[140:155]
    ds_read_b64_tr_b16 v[86:87], v18 offset:17408
    ds_read_b64_tr_b16 v[88:89], v18 offset:24576
    v_mfma_f32_32x32x16_bf16 v[156:171], v[116:119], v[100:103], v[156:171]
    ds_read_b64_tr_b16 v[90:91], v18 offset:25600
    ds_read_b64_tr_b16 v[92:93], v19 offset:16384
    v_mfma_f32_32x32x16_bf16 v[172:187], v[120:123], v[100:103], v[172:187]
    ds_read_b64_tr_b16 v[94:95], v19 offset:17408
    ds_read_b64_tr_b16 v[96:97], v19 offset:24576
    v_mfma_f32_32x32x16_bf16 v[188:203], v[108:111], v[104:107], v[188:203]
    ds_read_b64_tr_b16 v[98:99], v19 offset:25600
    ds_read_b128 v[80:83], v15 offset:4096
    v_mfma_f32_32x32x16_bf16 v[204:219], v[112:115], v[104:107], v[204:219]
    v_mfma_f32_32x32x16_bf16 v[220:235], v[116:119], v[104:107], v[220:235]
    v_mfma_f32_32x32x16_bf16 v[236:251], v[120:123], v[104:107], v[236:251]
    s_waitcnt lgkmcnt(0)
    v_mfma_f32_32x32x16_bf16 v[124:139], v[84:87], v[76:79], v[124:139]
    ds_read_b128 v[100:103], v16
    ds_read_b64_tr_b16 v[108:109], v18 offset:20480
    v_mfma_f32_32x32x16_bf16 v[140:155], v[88:91], v[76:79], v[140:155]
    ds_read_b64_tr_b16 v[110:111], v18 offset:21504
    ds_read_b64_tr_b16 v[112:113], v18 offset:28672
    v_mfma_f32_32x32x16_bf16 v[156:171], v[92:95], v[76:79], v[156:171]
    ds_read_b64_tr_b16 v[114:115], v18 offset:29696
    ds_read_b64_tr_b16 v[116:117], v19 offset:20480
    v_mfma_f32_32x32x16_bf16 v[172:187], v[96:99], v[76:79], v[172:187]
    ds_read_b64_tr_b16 v[118:119], v19 offset:21504
    ds_read_b64_tr_b16 v[120:121], v19 offset:28672
    v_mfma_f32_32x32x16_bf16 v[188:203], v[84:87], v[80:83], v[188:203]
    ds_read_b64_tr_b16 v[122:123], v19 offset:29696
    ds_read_b128 v[104:107], v16 offset:4096
    v_mfma_f32_32x32x16_bf16 v[204:219], v[88:91], v[80:83], v[204:219]
    s_lshl_b32 s34, s70, 1
    s_add_u32 s34, s34, -2
    s_sub_u32 s34, s34, s28
    s_and_b32 s34, s34, 0xfffffffb
    s_cbranch_scc1 Lpf8
    buffer_load_dword v60, v252, s[20:23], s96 offen
    s_mov_b64 exec, -1
    s_add_u32 s96, s96, 917504
    s_cmp_ge_u32 s96, 1835008
    s_cselect_b32 s34, 1835008, 0
    s_sub_u32 s96, s96, s34
Lpf8:
    v_mfma_f32_32x32x16_bf16 v[220:235], v[92:95], v[80:83], v[220:235]
    v_mfma_f32_32x32x16_bf16 v[236:251], v[96:99], v[80:83], v[236:251]
    s_waitcnt lgkmcnt(0)
    v_mfma_f32_32x32x16_bf16 v[124:139], v[108:111], v[100:103], v[124:139]
    s_add_u32 s69, s69, 16384
    s_cmp_eq_u32 s69, 114688
    s_cselect_b32 s69, 65536, s69
    v_xor_b32 v18, 0x8000, v18
    v_xor_b32 v19, 0x8000, v19
    v_add_u32 v13, s69, v9
    s_barrier
    ds_read_b128 v[76:79], v13
    ds_read_b64_tr_b16 v[84:85], v18 offset:0
    v_mfma_f32_32x32x16_bf16 v[140:155], v[112:115], v[100:103], v[140:155]
    ds_read_b64_tr_b16 v[86:87], v18 offset:1024
    ds_read_b64_tr_b16 v[88:89], v18 offset:8192
    v_mfma_f32_32x32x16_bf16 v[156:171], v[116:119], v[100:103], v[156:171]
    ds_read_b64_tr_b16 v[90:91], v18 offset:9216
    ds_read_b64_tr_b16 v[92:93], v19 offset:0
    v_mfma_f32_32x32x16_bf16 v[172:187], v[120:123], v[100:103], v[172:187]
    ds_read_b64_tr_b16 v[94:95], v19 offset:1024
    ds_read_b64_tr_b16 v[96:97], v19 offset:8192
    v_mfma_f32_32x32x16_bf16 v[188:203], v[108:111], v[104:107], v[188:203]
    ds_read_b64_tr_b16 v[98:99], v19 offset:9216
    ds_read_b128 v[80:83], v13 offset:4096
    v_mfma_f32_32x32x16_bf16 v[204:219], v[112:115], v[104:107], v[204:219]
    v_mfma_f32_32x32x16_bf16 v[220:235], v[116:119], v[104:107], v[220:235]
    v_mfma_f32_32x32x16_bf16 v[236:251], v[120:123], v[104:107], v[236:251]
    v_add_u32 v14, s69, v10
    v_add_u32 v15, s69, v11
    v_add_u32 v16, s69, v12
    s_add_u32 s70, s70, 1
    s_cmp_lt_u32 s70, 7
    s_cbranch_scc1 C_loop
    s_waitcnt lgkmcnt(0)
    v_mfma_f32_32x32x16_bf16 v[124:139], v[84:87], v[76:79], v[124:139]
    s_waitcnt vmcnt(0)
    ds_read_b128 v[100:103], v14
    ds_read_b64_tr_b16 v[108:109], v18 offset:4096
    ds_read_b64_tr_b16 v[110:111], v18 offset:5120
    v_mfma_f32_32x32x16_bf16 v[140:155], v[88:91], v[76:79], v[140:155]
    ds_read_b128 v[28:31], v15
    ds_read_b64_tr_b16 v[36:37], v18 offset:16384
    ds_read_b64_tr_b16 v[38:39], v18 offset:17408
    v_mfma_f32_32x32x16_bf16 v[156:171], v[92:95], v[76:79], v[156:171]
    ds_read_b128 v[52:55], v16
    ds_read_b64_tr_b16 v[60:61], v18 offset:20480
    ds_read_b64_tr_b16 v[62:63], v18 offset:21504
    v_mfma_f32_32x32x16_bf16 v[172:187], v[96:99], v[76:79], v[172:187]
    ds_read_b64_tr_b16 v[112:113], v18 offset:12288
    ds_read_b64_tr_b16 v[114:115], v18 offset:13312
    ds_read_b64_tr_b16 v[40:41], v18 offset:24576
    v_mfma_f32_32x32x16_bf16 v[188:203], v[84:87], v[80:83], v[188:203]
    ds_read_b64_tr_b16 v[42:43], v18 offset:25600
    ds_read_b64_tr_b16 v[64:65], v18 offset:28672
    ds_read_b64_tr_b16 v[66:67], v18 offset:29696
    s_waitcnt lgkmcnt(9)
    v_mfma_f32_32x32x16_bf16 v[204:219], v[88:91], v[80:83], v[204:219]
    ds_read_b64_tr_b16 v[116:117], v19 offset:4096
    ds_read_b64_tr_b16 v[118:119], v19 offset:5120
    v_mfma_f32_32x32x16_bf16 v[220:235], v[92:95], v[80:83], v[220:235]
    ds_read_b64_tr_b16 v[120:121], v19 offset:12288
    ds_read_b64_tr_b16 v[122:123], v19 offset:13312
    v_mfma_f32_32x32x16_bf16 v[236:251], v[96:99], v[80:83], v[236:251]
    ds_read_b64_tr_b16 v[44:45], v19 offset:16384
    ds_read_b64_tr_b16 v[46:47], v19 offset:17408
    s_waitcnt lgkmcnt(6)
    v_mfma_f32_32x32x16_bf16 v[124:139], v[108:111], v[100:103], v[124:139]
    ds_read_b64_tr_b16 v[48:49], v19 offset:24576
    ds_read_b64_tr_b16 v[50:51], v19 offset:25600
    ds_read_b64_tr_b16 v[68:69], v19 offset:20480
    v_mfma_f32_32x32x16_bf16 v[124:139], v[36:39], v[28:31], v[124:139]
    ds_read_b64_tr_b16 v[70:71], v19 offset:21504
    ds_read_b64_tr_b16 v[72:73], v19 offset:28672
    ds_read_b64_tr_b16 v[74:75], v19 offset:29696
    v_mfma_f32_32x32x16_bf16 v[124:139], v[60:63], v[52:55], v[124:139]
    ds_read_b128 v[104:107], v14 offset:4096
    ds_read_b128 v[32:35], v15 offset:4096
    ds_read_b128 v[56:59], v16 offset:4096
    v_mfma_f32_32x32x16_bf16 v[140:155], v[112:115], v[100:103], v[140:155]
    v_mfma_f32_32x32x16_bf16 v[140:155], v[40:43], v[28:31], v[140:155]
    v_mfma_f32_32x32x16_bf16 v[140:155], v[64:67], v[52:55], v[140:155]
    s_nop 5
    v_mul_f32 v124, s78, v124
    v_mul_f32 v125, s78, v125
    v_exp_f32 v124, v124
    v_mul_f32 v126, s78, v126
    v_exp_f32 v125, v125
    s_waitcnt lgkmcnt(0)
    v_mfma_f32_32x32x16_bf16 v[156:171], v[116:119], v[100:103], v[156:171]
    s_barrier
    v_add_f32 v124, 1.0, v124
    v_mul_f32 v127, s78, v127
    v_exp_f32 v126, v126
    v_add_f32 v125, 1.0, v125
    v_rcp_f32 v124, v124
    v_mfma_f32_32x32x16_bf16 v[156:171], v[44:47], v[28:31], v[156:171]
    v_mul_f32 v128, s78, v128
    v_exp_f32 v127, v127
    v_add_f32 v126, 1.0, v126
    v_rcp_f32 v125, v125
    v_mul_f32 v124, v124, v140
    v_mfma_f32_32x32x16_bf16 v[156:171], v[68:71], v[52:55], v[156:171]
    v_mul_f32 v129, s78, v129
    v_exp_f32 v128, v128
    v_add_f32 v127, 1.0, v127
    v_rcp_f32 v126, v126
    v_mul_f32 v125, v125, v141
    v_mfma_f32_32x32x16_bf16 v[172:187], v[120:123], v[100:103], v[172:187]
    v_mul_f32 v130, s78, v130
    v_exp_f32 v129, v129
    v_add_f32 v128, 1.0, v128
    v_rcp_f32 v127, v127
    v_mul_f32 v126, v126, v142
    v_mfma_f32_32x32x16_bf16 v[172:187], v[48:51], v[28:31], v[172:187]
    v_mul_f32 v131, s78, v131
    v_exp_f32 v130, v130
    v_add_f32 v129, 1.0, v129
    v_rcp_f32 v128, v128
    v_mul_f32 v127, v127, v143
    v_mfma_f32_32x32x16_bf16 v[172:187], v[72:75], v[52:55], v[172:187]
    v_exp_f32 v131, v131
    v_add_f32 v130, 1.0, v130
    v_rcp_f32 v129, v129
    v_mul_f32 v128, v128, v144
    v_add_f32 v131, 1.0, v131
    v_mfma_f32_32x32x16_bf16 v[188:203], v[108:111], v[104:107], v[188:203]
    v_rcp_f32 v130, v130
    v_mul_f32 v129, v129, v145
    v_rcp_f32 v131, v131
    v_mul_f32 v130, v130, v146
    v_mul_f32 v131, v131, v147
    v_mfma_f32_32x32x16_bf16 v[188:203], v[36:39], v[32:35], v[188:203]
    v_cvt_pk_bf16_f32 v140, v124, v125
    v_cvt_pk_bf16_f32 v141, v126, v127
    v_cvt_pk_bf16_f32 v142, v128, v129
    v_cvt_pk_bf16_f32 v143, v130, v131
    buffer_store_dwordx4 v[140:143], v17, s[16:19], s73 offen offset:0 sc1
    v_mfma_f32_32x32x16_bf16 v[188:203], v[60:63], v[56:59], v[188:203]
    v_mul_f32 v132, s78, v132
    v_mul_f32 v133, s78, v133
    v_exp_f32 v132, v132
    v_mul_f32 v134, s78, v134
    v_exp_f32 v133, v133
    v_mfma_f32_32x32x16_bf16 v[204:219], v[112:115], v[104:107], v[204:219]
    v_add_f32 v132, 1.0, v132
    v_mul_f32 v135, s78, v135
    v_exp_f32 v134, v134
    v_add_f32 v133, 1.0, v133
    v_rcp_f32 v132, v132
    v_mfma_f32_32x32x16_bf16 v[204:219], v[40:43], v[32:35], v[204:219]
    v_mul_f32 v136, s78, v136
    v_exp_f32 v135, v135
    v_add_f32 v134, 1.0, v134
    v_rcp_f32 v133, v133
    v_mul_f32 v132, v132, v148
    v_mfma_f32_32x32x16_bf16 v[204:219], v[64:67], v[56:59], v[204:219]
    v_mul_f32 v137, s78, v137
    v_exp_f32 v136, v136
    v_add_f32 v135, 1.0, v135
    v_rcp_f32 v134, v134
    v_mul_f32 v133, v133, v149
    v_mfma_f32_32x32x16_bf16 v[220:235], v[116:119], v[104:107], v[220:235]
    v_mul_f32 v138, s78, v138
    v_exp_f32 v137, v137
    v_add_f32 v136, 1.0, v136
    v_rcp_f32 v135, v135
    v_mul_f32 v134, v134, v150
    v_mfma_f32_32x32x16_bf16 v[220:235], v[44:47], v[32:35], v[220:235]
    v_mul_f32 v139, s78, v139
    v_exp_f32 v138, v138
    v_add_f32 v137, 1.0, v137
    v_rcp_f32 v136, v136
    v_mul_f32 v135, v135, v151
    v_mfma_f32_32x32x16_bf16 v[220:235], v[68:71], v[56:59], v[220:235]
    v_exp_f32 v139, v139
    v_add_f32 v138, 1.0, v138
    v_rcp_f32 v137, v137
    v_mul_f32 v136, v136, v152
    v_add_f32 v139, 1.0, v139
    v_mfma_f32_32x32x16_bf16 v[236:251], v[120:123], v[104:107], v[236:251]
    v_rcp_f32 v138, v138
    v_mul_f32 v137, v137, v153
    v_rcp_f32 v139, v139
    v_mul_f32 v138, v138, v154
    v_mul_f32 v139, v139, v155
    v_mfma_f32_32x32x16_bf16 v[236:251], v[48:51], v[32:35], v[236:251]
    v_cvt_pk_bf16_f32 v148, v132, v133
    v_cvt_pk_bf16_f32 v149, v134, v135
    v_cvt_pk_bf16_f32 v150, v136, v137
    v_cvt_pk_bf16_f32 v151, v138, v139
    buffer_store_dwordx4 v[148:151], v17, s[16:19], s73 offen offset:1024 sc1
    v_mfma_f32_32x32x16_bf16 v[236:251], v[72:75], v[56:59], v[236:251]
    v_pk_mul_f32 v[156:157], v[156:157], s[78:79]
    v_pk_mul_f32 v[158:159], v[158:159], s[78:79]
    v_pk_mul_f32 v[160:161], v[160:161], s[78:79]
    v_pk_mul_f32 v[162:163], v[162:163], s[78:79]
    v_exp_f32 v156, v156
    v_exp_f32 v157, v157
    v_exp_f32 v158, v158
    v_exp_f32 v159, v159
    v_exp_f32 v160, v160
    v_exp_f32 v161, v161
    v_exp_f32 v162, v162
    v_exp_f32 v163, v163
    v_pk_add_f32 v[156:157], v[156:157], 1.0 op_sel_hi:[1,0]
    v_pk_add_f32 v[158:159], v[158:159], 1.0 op_sel_hi:[1,0]
    v_pk_add_f32 v[160:161], v[160:161], 1.0 op_sel_hi:[1,0]
    v_pk_add_f32 v[162:163], v[162:163], 1.0 op_sel_hi:[1,0]
    v_rcp_f32 v156, v156
    v_rcp_f32 v157, v157
    v_rcp_f32 v158, v158
    v_rcp_f32 v159, v159
    v_rcp_f32 v160, v160
    v_rcp_f32 v161, v161
    v_rcp_f32 v162, v162
    v_rcp_f32 v163, v163
    v_pk_mul_f32 v[156:157], v[156:157], v[172:173]
    v_pk_mul_f32 v[158:159], v[158:159], v[174:175]
    v_pk_mul_f32 v[160:161], v[160:161], v[176:177]
    v_pk_mul_f32 v[162:163], v[162:163], v[178:179]
    v_cvt_pk_bf16_f32 v172, v156, v157
    v_cvt_pk_bf16_f32 v173, v158, v159
    v_cvt_pk_bf16_f32 v174, v160, v161
    v_cvt_pk_bf16_f32 v175, v162, v163
    buffer_store_dwordx4 v[172:175], v17, s[16:19], s73 offen offset:2048 sc1
    v_pk_mul_f32 v[164:165], v[164:165], s[78:79]
    v_pk_mul_f32 v[166:167], v[166:167], s[78:79]
    v_pk_mul_f32 v[168:169], v[168:169], s[78:79]
    v_pk_mul_f32 v[170:171], v[170:171], s[78:79]
    v_exp_f32 v164, v164
    v_exp_f32 v165, v165
    v_exp_f32 v166, v166
    v_exp_f32 v167, v167
    v_exp_f32 v168, v168
    v_exp_f32 v169, v169
    v_exp_f32 v170, v170
    v_exp_f32 v171, v171
    v_pk_add_f32 v[164:165], v[164:165], 1.0 op_sel_hi:[1,0]
    v_pk_add_f32 v[166:167], v[166:167], 1.0 op_sel_hi:[1,0]
    v_pk_add_f32 v[168:169], v[168:169], 1.0 op_sel_hi:[1,0]
    v_pk_add_f32 v[170:171], v[170:171], 1.0 op_sel_hi:[1,0]
    v_rcp_f32 v164, v164
    v_rcp_f32 v165, v165
    v_rcp_f32 v166, v166
    v_rcp_f32 v167, v167
    v_rcp_f32 v168, v168
    v_rcp_f32 v169, v169
    v_rcp_f32 v170, v170
    v_rcp_f32 v171, v171
    v_pk_mul_f32 v[164:165], v[164:165], v[180:181]
    v_pk_mul_f32 v[166:167], v[166:167], v[182:183]
    v_pk_mul_f32 v[168:169], v[168:169], v[184:185]
    v_pk_mul_f32 v[170:171], v[170:171], v[186:187]
    v_cvt_pk_bf16_f32 v180, v164, v165
    v_cvt_pk_bf16_f32 v181, v166, v167
    v_cvt_pk_bf16_f32 v182, v168, v169
    v_cvt_pk_bf16_f32 v183, v170, v171
    buffer_store_dwordx4 v[180:183], v17, s[16:19], s73 offen offset:3072 sc1
    v_pk_mul_f32 v[188:189], v[188:189], s[78:79]
    v_pk_mul_f32 v[190:191], v[190:191], s[78:79]
    v_pk_mul_f32 v[192:193], v[192:193], s[78:79]
    v_pk_mul_f32 v[194:195], v[194:195], s[78:79]
    v_exp_f32 v188, v188
    v_exp_f32 v189, v189
    v_exp_f32 v190, v190
    v_exp_f32 v191, v191
    v_exp_f32 v192, v192
    v_exp_f32 v193, v193
    v_exp_f32 v194, v194
    v_exp_f32 v195, v195
    v_pk_add_f32 v[188:189], v[188:189], 1.0 op_sel_hi:[1,0]
    v_pk_add_f32 v[190:191], v[190:191], 1.0 op_sel_hi:[1,0]
    v_pk_add_f32 v[192:193], v[192:193], 1.0 op_sel_hi:[1,0]
    v_pk_add_f32 v[194:195], v[194:195], 1.0 op_sel_hi:[1,0]
    v_rcp_f32 v188, v188
    v_rcp_f32 v189, v189
    v_rcp_f32 v190, v190
    v_rcp_f32 v191, v191
    v_rcp_f32 v192, v192
    v_rcp_f32 v193, v193
    v_rcp_f32 v194, v194
    v_rcp_f32 v195, v195
    v_pk_mul_f32 v[188:189], v[188:189], v[204:205]
    v_pk_mul_f32 v[190:191], v[190:191], v[206:207]
    v_pk_mul_f32 v[192:193], v[192:193], v[208:209]
    v_pk_mul_f32 v[194:195], v[194:195], v[210:211]
    v_cvt_pk_bf16_f32 v204, v188, v189
    v_cvt_pk_bf16_f32 v205, v190, v191
    v_cvt_pk_bf16_f32 v206, v192, v193
    v_cvt_pk_bf16_f32 v207, v194, v195
    buffer_store_dwordx4 v[204:207], v17, s[16:19], s74 offen offset:0 sc1
    v_pk_mul_f32 v[196:197], v[196:197], s[78:79]
    v_pk_mul_f32 v[198:199], v[198:199], s[78:79]
    v_pk_mul_f32 v[200:201], v[200:201], s[78:79]
    v_pk_mul_f32 v[202:203], v[202:203], s[78:79]
    v_exp_f32 v196, v196
    v_exp_f32 v197, v197
    v_exp_f32 v198, v198
    v_exp_f32 v199, v199
    v_exp_f32 v200, v200
    v_exp_f32 v201, v201
    v_exp_f32 v202, v202
    v_exp_f32 v203, v203
    v_pk_add_f32 v[196:197], v[196:197], 1.0 op_sel_hi:[1,0]
    v_pk_add_f32 v[198:199], v[198:199], 1.0 op_sel_hi:[1,0]
    v_pk_add_f32 v[200:201], v[200:201], 1.0 op_sel_hi:[1,0]
    v_pk_add_f32 v[202:203], v[202:203], 1.0 op_sel_hi:[1,0]
    v_rcp_f32 v196, v196
    v_rcp_f32 v197, v197
    v_rcp_f32 v198, v198
    v_rcp_f32 v199, v199
    v_rcp_f32 v200, v200
    v_rcp_f32 v201, v201
    v_rcp_f32 v202, v202
    v_rcp_f32 v203, v203
    v_pk_mul_f32 v[196:197], v[196:197], v[212:213]
    v_pk_mul_f32 v[198:199], v[198:199], v[214:215]
    v_pk_mul_f32 v[200:201], v[200:201], v[216:217]
    v_pk_mul_f32 v[202:203], v[202:203], v[218:219]
    v_cvt_pk_bf16_f32 v212, v196, v197
    v_cvt_pk_bf16_f32 v213, v198, v199
    v_cvt_pk_bf16_f32 v214, v200, v201
    v_cvt_pk_bf16_f32 v215, v202, v203
    buffer_store_dwordx4 v[212:215], v17, s[16:19], s74 offen offset:1024 sc1
    v_pk_mul_f32 v[220:221], v[220:221], s[78:79]
    v_pk_mul_f32 v[222:223], v[222:223], s[78:79]
    v_pk_mul_f32 v[224:225], v[224:225], s[78:79]
    v_pk_mul_f32 v[226:227], v[226:227], s[78:79]
    v_exp_f32 v220, v220
    v_exp_f32 v221, v221
    v_exp_f32 v222, v222
    v_exp_f32 v223, v223
    v_exp_f32 v224, v224
    v_exp_f32 v225, v225
    v_exp_f32 v226, v226
    v_exp_f32 v227, v227
    v_pk_add_f32 v[220:221], v[220:221], 1.0 op_sel_hi:[1,0]
    v_pk_add_f32 v[222:223], v[222:223], 1.0 op_sel_hi:[1,0]
    v_pk_add_f32 v[224:225], v[224:225], 1.0 op_sel_hi:[1,0]
    v_pk_add_f32 v[226:227], v[226:227], 1.0 op_sel_hi:[1,0]
    v_rcp_f32 v220, v220
    v_rcp_f32 v221, v221
    v_rcp_f32 v222, v222
    v_rcp_f32 v223, v223
    v_rcp_f32 v224, v224
    v_rcp_f32 v225, v225
    v_rcp_f32 v226, v226
    v_rcp_f32 v227, v227
    v_pk_mul_f32 v[220:221], v[220:221], v[236:237]
    v_pk_mul_f32 v[222:223], v[222:223], v[238:239]
    v_pk_mul_f32 v[224:225], v[224:225], v[240:241]
    v_pk_mul_f32 v[226:227], v[226:227], v[242:243]
    v_cvt_pk_bf16_f32 v236, v220, v221
    v_cvt_pk_bf16_f32 v237, v222, v223
    v_cvt_pk_bf16_f32 v238, v224, v225
    v_cvt_pk_bf16_f32 v239, v226, v227
    buffer_store_dwordx4 v[236:239], v17, s[16:19], s74 offen offset:2048 sc1
    v_pk_mul_f32 v[228:229], v[228:229], s[78:79]
    v_pk_mul_f32 v[230:231], v[230:231], s[78:79]
    v_pk_mul_f32 v[232:233], v[232:233], s[78:79]
    v_pk_mul_f32 v[234:235], v[234:235], s[78:79]
    v_exp_f32 v228, v228
    v_exp_f32 v229, v229
    v_exp_f32 v230, v230
    v_exp_f32 v231, v231
    v_exp_f32 v232, v232
    v_exp_f32 v233, v233
    v_exp_f32 v234, v234
    v_exp_f32 v235, v235
    v_pk_add_f32 v[228:229], v[228:229], 1.0 op_sel_hi:[1,0]
    v_pk_add_f32 v[230:231], v[230:231], 1.0 op_sel_hi:[1,0]
    v_pk_add_f32 v[232:233], v[232:233], 1.0 op_sel_hi:[1,0]
    v_pk_add_f32 v[234:235], v[234:235], 1.0 op_sel_hi:[1,0]
    v_rcp_f32 v228, v228
    v_rcp_f32 v229, v229
    v_rcp_f32 v230, v230
    v_rcp_f32 v231, v231
    v_rcp_f32 v232, v232
    v_rcp_f32 v233, v233
    v_rcp_f32 v234, v234
    v_rcp_f32 v235, v235
    v_pk_mul_f32 v[228:229], v[228:229], v[244:245]
    v_pk_mul_f32 v[230:231], v[230:231], v[246:247]
    v_pk_mul_f32 v[232:233], v[232:233], v[248:249]
    v_pk_mul_f32 v[234:235], v[234:235], v[250:251]
    v_cvt_pk_bf16_f32 v244, v228, v229
    v_cvt_pk_bf16_f32 v245, v230, v231
    v_cvt_pk_bf16_f32 v246, v232, v233
    v_cvt_pk_bf16_f32 v247, v234, v235
    buffer_store_dwordx4 v[244:247], v17, s[16:19], s74 offen offset:3072 sc1
    s_mov_b64 exec, 1
    ds_add_u32 v7, v8 offset:12
    s_mov_b64 exec, -1
    s_waitcnt vmcnt(8)
    v_mov_b32 v4, 0
    s_mov_b32 s75, 0
Ltok9:
    v_readfirstlane_b32 s68, v5
    s_add_u32 s75, s75, 1
    s_cmp_lg_u32 s68, 0
    s_cbranch_scc1 Ltok9_ok
    global_load_dword v5, v4, s[66:67] sc1
    s_waitcnt vmcnt(0)
    s_cmp_lt_u32 s75, 131072
    s_cbranch_scc1 Ltok9
Ltok9_ok:
    s_mov_b32 s75, 0
Llw10:
    ds_read_b32 v2, v7 offset:0
    s_add_u32 s75, s75, 1
    s_waitcnt lgkmcnt(0)
    v_readfirstlane_b32 s34, v2
    s_nop 0
    s_cmp_ge_u32 s34, 4
    s_cbranch_scc1 Llw10_ok
    s_sleep 0
    s_cmp_lt_u32 s75, 2097152
    s_cbranch_scc1 Llw10
Llw10_ok:
    ds_read_b64_tr_b16 v[28:29], v22 offset:49152
    ds_read_b64_tr_b16 v[30:31], v22 offset:50176
    ds_read_b64_tr_b16 v[32:33], v23 offset:49152
    ds_read_b64_tr_b16 v[34:35], v23 offset:50176
    ds_read_b64_tr_b16 v[36:37], v22 offset:57344
    ds_read_b64_tr_b16 v[38:39], v22 offset:58368
    ds_read_b64_tr_b16 v[40:41], v23 offset:57344
    ds_read_b64_tr_b16 v[42:43], v23 offset:58368
    s_mov_b64 exec, 1
    ds_add_u32 v7, v8 offset:8
    s_mov_b64 exec, -1
    ds_read_b64_tr_b16 v[44:45], v22 offset:0
    ds_read_b64_tr_b16 v[46:47], v22 offset:1024
    ds_read_b64_tr_b16 v[48:49], v23 offset:0
    ds_read_b64_tr_b16 v[50:51], v23 offset:1024
    ds_read_b64_tr_b16 v[52:53], v22 offset:8192
    ds_read_b64_tr_b16 v[54:55], v22 offset:9216
    ds_read_b64_tr_b16 v[56:57], v23 offset:8192
    ds_read_b64_tr_b16 v[58:59], v23 offset:9216
    s_waitcnt lgkmcnt(6)
    ds_read_b64_tr_b16 v[60:61], v20 offset:0
    ds_read_b64_tr_b16 v[62:63], v20 offset:1024
    ds_read_b64_tr_b16 v[64:65], v21 offset:0
    ds_read_b64_tr_b16 v[66:67], v21 offset:1024
    ds_read_b64_tr_b16 v[68:69], v20 offset:8192
    ds_read_b64_tr_b16 v[70:71], v20 offset:9216
    ds_read_b64_tr_b16 v[72:73], v21 offset:8192
    ds_read_b64_tr_b16 v[74:75], v21 offset:9216
    s_waitcnt lgkmcnt(6)
    ds_read_b64_tr_b16 v[76:77], v20 offset:16384
    ds_read_b64_tr_b16 v[78:79], v20 offset:17408
    ds_read_b64_tr_b16 v[80:81], v21 offset:16384
    ds_read_b64_tr_b16 v[82:83], v21 offset:17408
    ds_read_b64_tr_b16 v[84:85], v20 offset:24576
    ds_read_b64_tr_b16 v[86:87], v20 offset:25600
    ds_read_b64_tr_b16 v[88:89], v21 offset:24576
    ds_read_b64_tr_b16 v[90:91], v21 offset:25600
    s_waitcnt lgkmcnt(6)
    ds_read_b64_tr_b16 v[92:93], v22 offset:16384
    ds_read_b64_tr_b16 v[94:95], v22 offset:17408
    ds_read_b64_tr_b16 v[96:97], v23 offset:16384
    ds_read_b64_tr_b16 v[98:99], v23 offset:17408
    ds_read_b64_tr_b16 v[100:101], v22 offset:24576
    ds_read_b64_tr_b16 v[102:103], v22 offset:25600
    ds_read_b64_tr_b16 v[104:105], v23 offset:24576
    ds_read_b64_tr_b16 v[106:107], v23 offset:25600
    s_waitcnt lgkmcnt(6)
    ds_read_b64_tr_b16 v[108:109], v20 offset:32768
    ds_read_b64_tr_b16 v[110:111], v20 offset:33792
    ds_read_b64_tr_b16 v[112:113], v21 offset:32768
    ds_read_b64_tr_b16 v[114:115], v21 offset:33792
    ds_read_b64_tr_b16 v[116:117], v20 offset:40960
    ds_read_b64_tr_b16 v[118:119], v20 offset:41984
    ds_read_b64_tr_b16 v[120:121], v21 offset:40960
    ds_read_b64_tr_b16 v[122:123], v21 offset:41984
    s_waitcnt lgkmcnt(6)
    s_waitcnt vmcnt(0)
    s_mov_b64 exec, 1
    buffer_store_dword v5, v4, s[16:19], s71 offen sc1
    s_mov_b64 exec, -1
C_p2:
    s_mov_b32 s69, 14680064
    s_waitcnt lgkmcnt(0)
    s_add_u32 m0, s72, 49152
    s_add_u32 s34, s83, 0
    buffer_load_dwordx4 v24, s[20:23], s34 offen lds
    s_add_u32 m0, s72, 50176
    s_add_u32 s34, s83, 8192
    buffer_load_dwordx4 v24, s[20:23], s34 offen lds
    s_add_u32 m0, s72, 57344
    s_add_u32 s34, s83, 16384
    buffer_load_dwordx4 v24, s[20:23], s34 offen lds
    s_add_u32 m0, s72, 58368
    s_add_u32 s34, s83, 24576
    buffer_load_dwordx4 v24, s[20:23], s34 offen lds
    s_add_u32 m0, s72, 65536
    s_add_u32 s34, s83, 32768
    buffer_load_dwordx4 v24, s[20:23], s34 offen lds
    s_add_u32 m0, s72, 66560
    s_add_u32 s34, s83, 40960
    buffer_load_dwordx4 v24, s[20:23], s34 offen lds
    s_add_u32 m0, s72, 73728
    s_add_u32 s34, s83, 49152
    buffer_load_dwordx4 v24, s[20:23], s34 offen lds
    s_add_u32 m0, s72, 74752
    s_add_u32 s34, s83, 57344
    buffer_load_dwordx4 v24, s[20:23], s34 offen lds
    s_add_u32 m0, s72, 0
    s_add_u32 s34, s84, 0
    buffer_load_dwordx4 v24, s[20:23], s34 offen lds
    s_add_u32 m0, s72, 1024
    s_add_u32 s34, s84, 8192
    buffer_load_dwordx4 v24, s[20:23], s34 offen lds
    s_mov_b64 exec, 0x7f
    buffer_load_dword v3, v252, s[16:19], s95 offen sc1
    s_mov_b64 exec, -1
    s_add_u32 m0, s72, 8192
    s_add_u32 s34, s84, 16384
    buffer_load_dwordx4 v24, s[20:23], s34 offen lds
    s_add_u32 m0, s72, 9216
    s_add_u32 s34, s84, 24576
    buffer_load_dwordx4 v24, s[20:23], s34 offen lds
    s_add_u32 m0, s72, 16384
    s_add_u32 s34, s84, 32768
    buffer_load_dwordx4 v24, s[20:23], s34 offen lds
    s_add_u32 m0, s72, 17408
    s_add_u32 s34, s84, 40960
    buffer_load_dwordx4 v24, s[20:23], s34 offen lds
    s_add_u32 m0, s72, 24576
    s_add_u32 s34, s84, 49152
    buffer_load_dwordx4 v24, s[20:23], s34 offen lds
    s_add_u32 m0, s72, 25600
    s_add_u32 s34, s84, 57344
    buffer_load_dwordx4 v24, s[20:23], s34 offen lds
    s_add_u32 m0, s72, 81920
    s_add_u32 s34, s85, 0
    buffer_load_dwordx4 v24, s[20:23], s34 offen lds
    s_add_u32 m0, s72, 82944
    s_add_u32 s34, s85, 8192
    buffer_load_dwordx4 v24, s[20:23], s34 offen lds
    s_add_u32 m0, s72, 90112
    s_add_u32 s34, s85, 16384
    buffer_load_dwordx4 v24, s[20:23], s34 offen lds
    s_add_u32 m0, s72, 91136
    s_add_u32 s34, s85, 24576
    buffer_load_dwordx4 v24, s[20:23], s34 offen lds
    s_add_u32 m0, s72, 32768
    s_add_u32 s34, s85, 32768
    buffer_load_dwordx4 v24, s[20:23], s34 offen lds
    s_add_u32 m0, s72, 33792
    s_add_u32 s34, s85, 40960
    buffer_load_dwordx4 v24, s[20:23], s34 offen lds
    s_add_u32 m0, s72, 40960
    s_add_u32 s34, s85, 49152
    buffer_load_dwordx4 v24, s[20:23], s34 offen lds
    s_add_u32 m0, s72, 41984
    s_add_u32 s34, s85, 57344
    buffer_load_dwordx4 v24, s[20:23], s34 offen lds
    s_waitcnt vmcnt(14)
    s_mov_b32 s75, 0
    s_mov_b64 exec, 0x7f
Lpoll11:
    v_cmp_ne_u32 vcc, s68, v3
    s_add_u32 s75, s75, 1
    s_cbranch_vccz Lpoll11_ok
    s_sleep 2
    s_cmp_eq_u32 s31, 0
    s_cbranch_scc1 Lpoll11_ns
    s_sleep 8
Lpoll11_ns:
    buffer_load_dword v3, v252, s[16:19], s95 offen sc1
    s_waitcnt vmcnt(0)
    s_cmp_lt_u32 s75, 131072
    s_cbranch_scc1 Lpoll11
Lpoll11_ok:
    s_mov_b64 exec, -1
C_go:
    buffer_load_dwordx4 v[188:191], v26, s[16:19], s87 offen offset:0 sc1
    buffer_load_dwordx4 v[192:195], v27, s[16:19], s87 offen offset:0 sc1
    buffer_load_dwordx4 v[196:199], v26, s[16:19], s87 offen offset:1024 sc1
    buffer_load_dwordx4 v[200:203], v27, s[16:19], s87 offen offset:1024 sc1
    buffer_load_dwordx4 v[204:207], v26, s[16:19], s87 offen offset:2048 sc1
    buffer_load_dwordx4 v[208:211], v27, s[16:19], s87 offen offset:2048 sc1
    buffer_load_dwordx4 v[212:215], v26, s[16:19], s87 offen offset:3072 sc1
    buffer_load_dwordx4 v[216:219], v27, s[16:19], s87 offen offset:3072 sc1
    buffer_load_dwordx4 v[220:223], v26, s[16:19], s88 offen offset:0 sc1
    buffer_load_dwordx4 v[224:227], v27, s[16:19], s88 offen offset:0 sc1
    buffer_load_dwordx4 v[228:231], v26, s[16:19], s88 offen offset:1024 sc1
    buffer_load_dwordx4 v[232:235], v27, s[16:19], s88 offen offset:1024 sc1
    buffer_load_dwordx4 v[236:239], v26, s[16:19], s88 offen offset:2048 sc1
    buffer_load_dwordx4 v[240:243], v27, s[16:19], s88 offen offset:2048 sc1
    buffer_load_dwordx4 v[244:247], v26, s[16:19], s88 offen offset:3072 sc1
    buffer_load_dwordx4 v[248:251], v27, s[16:19], s88 offen offset:3072 sc1
    s_waitcnt vmcnt(14)
    v_mfma_f32_32x32x16_bf16 v[124:139], v[28:31], v[188:191], 0
    v_mfma_f32_32x32x16_bf16 v[140:155], v[28:31], v[192:195], 0
    v_mfma_f32_32x32x16_bf16 v[156:171], v[32:35], v[188:191], 0
    v_mfma_f32_32x32x16_bf16 v[172:187], v[32:35], v[192:195], 0
    s_waitcnt vmcnt(12)
    v_mfma_f32_32x32x16_bf16 v[124:139], v[36:39], v[196:199], v[124:139]
    v_mfma_f32_32x32x16_bf16 v[140:155], v[36:39], v[200:203], v[140:155]
    v_mfma_f32_32x32x16_bf16 v[156:171], v[40:43], v[196:199], v[156:171]
    v_mfma_f32_32x32x16_bf16 v[172:187], v[40:43], v[200:203], v[172:187]
    s_waitcnt vmcnt(10)
    v_mfma_f32_32x32x16_bf16 v[124:139], v[44:47], v[204:207], v[124:139]
    buffer_load_dwordx4 v[188:191], v26, s[16:19], s89 offen offset:0 sc1
    v_mfma_f32_32x32x16_bf16 v[140:155], v[44:47], v[208:211], v[140:155]
    buffer_load_dwordx4 v[192:195], v27, s[16:19], s89 offen offset:0 sc1
    v_mfma_f32_32x32x16_bf16 v[156:171], v[48:51], v[204:207], v[156:171]
    v_mfma_f32_32x32x16_bf16 v[172:187], v[48:51], v[208:211], v[172:187]
    s_waitcnt vmcnt(10)
    v_mfma_f32_32x32x16_bf16 v[124:139], v[52:55], v[212:215], v[124:139]
    buffer_load_dwordx4 v[196:199], v26, s[16:19], s89 offen offset:1024 sc1
    v_mfma_f32_32x32x16_bf16 v[140:155], v[52:55], v[216:219], v[140:155]
    buffer_load_dwordx4 v[200:203], v27, s[16:19], s89 offen offset:1024 sc1
    v_mfma_f32_32x32x16_bf16 v[156:171], v[56:59], v[212:215], v[156:171]
    v_mfma_f32_32x32x16_bf16 v[172:187], v[56:59], v[216:219], v[172:187]
    s_waitcnt vmcnt(10)
    v_mfma_f32_32x32x16_bf16 v[124:139], v[60:63], v[220:223], v[124:139]
    buffer_load_dwordx4 v[204:207], v26, s[16:19], s89 offen offset:2048 sc1
    v_mfma_f32_32x32x16_bf16 v[140:155], v[60:63], v[224:227], v[140:155]
    buffer_load_dwordx4 v[208:211], v27, s[16:19], s89 offen offset:2048 sc1
    v_mfma_f32_32x32x16_bf16 v[156:171], v[64:67], v[220:223], v[156:171]
    v_mfma_f32_32x32x16_bf16 v[172:187], v[64:67], v[224:227], v[172:187]
    s_waitcnt vmcnt(10)
    v_mfma_f32_32x32x16_bf16 v[124:139], v[68:71], v[228:231], v[124:139]
    buffer_load_dwordx4 v[44:47], v26, s[16:19], s89 offen offset:3072 sc1
    v_mfma_f32_32x32x16_bf16 v[140:155], v[68:71], v[232:235], v[140:155]
    buffer_load_dwordx4 v[48:51], v27, s[16:19], s89 offen offset:3072 sc1
    v_mfma_f32_32x32x16_bf16 v[156:171], v[72:75], v[228:231], v[156:171]
    v_mfma_f32_32x32x16_bf16 v[172:187], v[72:75], v[232:235], v[172:187]
    s_waitcnt vmcnt(10)
    v_mfma_f32_32x32x16_bf16 v[124:139], v[76:79], v[236:239], v[124:139]
    buffer_load_dwordx4 v[212:215], v26, s[16:19], s90 offen offset:0 sc1
    v_mfma_f32_32x32x16_bf16 v[140:155], v[76:79], v[240:243], v[140:155]
    buffer_load_dwordx4 v[216:219], v27, s[16:19], s90 offen offset:0 sc1
    v_mfma_f32_32x32x16_bf16 v[156:171], v[80:83], v[236:239], v[156:171]
    v_mfma_f32_32x32x16_bf16 v[172:187], v[80:83], v[240:243], v[172:187]
    s_waitcnt vmcnt(10)
    v_mfma_f32_32x32x16_bf16 v[124:139], v[84:87], v[244:247], v[124:139]
    buffer_load_dwordx4 v[52:55], v26, s[16:19], s90 offen offset:1024 sc1
    v_mfma_f32_32x32x16_bf16 v[140:155], v[84:87], v[248:251], v[140:155]
    buffer_load_dwordx4 v[56:59], v27, s[16:19], s90 offen offset:1024 sc1
    v_mfma_f32_32x32x16_bf16 v[156:171], v[88:91], v[244:247], v[156:171]
    v_mfma_f32_32x32x16_bf16 v[172:187], v[88:91], v[248:251], v[172:187]
    s_waitcnt vmcnt(10)
    v_mfma_f32_32x32x16_bf16 v[124:139], v[92:95], v[188:191], v[124:139]
    buffer_load_dwordx4 v[220:223], v26, s[16:19], s90 offen offset:2048 sc1
    v_mfma_f32_32x32x16_bf16 v[140:155], v[92:95], v[192:195], v[140:155]
    buffer_load_dwordx4 v[224:227], v27, s[16:19], s90 offen offset:2048 sc1
    v_mfma_f32_32x32x16_bf16 v[156:171], v[96:99], v[188:191], v[156:171]
    v_mfma_f32_32x32x16_bf16 v[172:187], v[96:99], v[192:195], v[172:187]
    s_waitcnt vmcnt(10)
    v_mfma_f32_32x32x16_bf16 v[124:139], v[100:103], v[196:199], v[124:139]
    buffer_load_dwordx4 v[60:63], v26, s[16:19], s90 offen offset:3072 sc1
    v_mfma_f32_32x32x16_bf16 v[140:155], v[100:103], v[200:203], v[140:155]
    buffer_load_dwordx4 v[64:67], v27, s[16:19], s90 offen offset:3072 sc1
    v_mfma_f32_32x32x16_bf16 v[156:171], v[104:107], v[196:199], v[156:171]
    v_mfma_f32_32x32x16_bf16 v[172:187], v[104:107], v[200:203], v[172:187]
    s_waitcnt vmcnt(10)
    v_mfma_f32_32x32x16_bf16 v[124:139], v[108:111], v[204:207], v[124:139]
    buffer_load_dwordx4 v[228:231], v26, s[16:19], s91 offen offset:0 sc1
    v_mfma_f32_32x32x16_bf16 v[140:155], v[108:111], v[208:211], v[140:155]
    buffer_load_dwordx4 v[232:235], v27, s[16:19], s91 offen offset:0 sc1
    v_mfma_f32_32x32x16_bf16 v[156:171], v[112:115], v[204:207], v[156:171]
    v_mfma_f32_32x32x16_bf16 v[172:187], v[112:115], v[208:211], v[172:187]
    s_waitcnt vmcnt(10)
    v_mfma_f32_32x32x16_bf16 v[124:139], v[116:119], v[44:47], v[124:139]
    ds_read_b64_tr_b16 v[28:29], v20 offset:49152
    ds_read_b64_tr_b16 v[30:31], v20 offset:50176
    buffer_load_dwordx4 v[68:71], v26, s[16:19], s91 offen offset:1024 sc1
    v_mfma_f32_32x32x16_bf16 v[140:155], v[116:119], v[48:51], v[140:155]
    ds_read_b64_tr_b16 v[32:33], v21 offset:49152
    ds_read_b64_tr_b16 v[34:35], v21 offset:50176
    buffer_load_dwordx4 v[72:75], v27, s[16:19], s91 offen offset:1024 sc1
    v_mfma_f32_32x32x16_bf16 v[156:171], v[120:123], v[44:47], v[156:171]
    v_mfma_f32_32x32x16_bf16 v[172:187], v[120:123], v[48:51], v[172:187]
    s_waitcnt vmcnt(10)
    s_waitcnt lgkmcnt(0)
    v_mfma_f32_32x32x16_bf16 v[124:139], v[28:31], v[212:215], v[124:139]
    ds_read_b64_tr_b16 v[36:37], v20 offset:57344
    ds_read_b64_tr_b16 v[38:39], v20 offset:58368
    buffer_load_dwordx4 v[236:239], v26, s[16:19], s91 offen offset:2048 sc1
    v_mfma_f32_32x32x16_bf16 v[140:155], v[28:31], v[216:219], v[140:155]
    ds_read_b64_tr_b16 v[40:41], v21 offset:57344
    ds_read_b64_tr_b16 v[42:43], v21 offset:58368
    buffer_load_dwordx4 v[240:243], v27, s[16:19], s91 offen offset:2048 sc1
    v_mfma_f32_32x32x16_bf16 v[156:171], v[32:35], v[212:215], v[156:171]
    v_mfma_f32_32x32x16_bf16 v[172:187], v[32:35], v[216:219], v[172:187]
    s_waitcnt vmcnt(10)
    s_waitcnt lgkmcnt(0)
    v_mfma_f32_32x32x16_bf16 v[124:139], v[36:39], v[52:55], v[124:139]
    ds_read_b64_tr_b16 v[28:29], v22 offset:0
    ds_read_b64_tr_b16 v[30:31], v22 offset:1024
    buffer_load_dwordx4 v[76:79], v26, s[16:19], s91 offen offset:3072 sc1
    v_mfma_f32_32x32x16_bf16 v[140:155], v[36:39], v[56:59], v[140:155]
    ds_read_b64_tr_b16 v[32:33], v23 offset:0
    ds_read_b64_tr_b16 v[34:35], v23 offset:1024
    buffer_load_dwordx4 v[80:83], v27, s[16:19], s91 offen offset:3072 sc1
    v_mfma_f32_32x32x16_bf16 v[156:171], v[40:43], v[52:55], v[156:171]
    s_add_u32 m0, s72, 49152
    s_add_u32 s34, s86, 0
    buffer_load_dwordx4 v24, s[20:23], s34 offen lds
    v_mfma_f32_32x32x16_bf16 v[172:187], v[40:43], v[56:59], v[172:187]
    s_add_u32 m0, s72, 50176
    s_add_u32 s34, s86, 8192
    buffer_load_dwordx4 v24, s[20:23], s34 offen lds
    s_waitcnt vmcnt(12)
    s_waitcnt lgkmcnt(0)
    v_mfma_f32_32x32x16_bf16 v[124:139], v[28:31], v[220:223], v[124:139]
    ds_read_b64_tr_b16 v[36:37], v22 offset:8192
    ds_read_b64_tr_b16 v[38:39], v22 offset:9216
    buffer_load_dwordx4 v[244:247], v26, s[16:19], s92 offen offset:0 sc1
    v_mfma_f32_32x32x16_bf16 v[140:155], v[28:31], v[224:227], v[140:155]
    ds_read_b64_tr_b16 v[40:41], v23 offset:8192
    ds_read_b64_tr_b16 v[42:43], v23 offset:9216
    buffer_load_dwordx4 v[248:251], v27, s[16:19], s92 offen offset:0 sc1
    v_mfma_f32_32x32x16_bf16 v[156:171], v[32:35], v[220:223], v[156:171]
    s_add_u32 m0, s72, 57344
    s_add_u32 s34, s86, 16384
    buffer_load_dwordx4 v24, s[20:23], s34 offen lds
    v_mfma_f32_32x32x16_bf16 v[172:187], v[32:35], v[224:227], v[172:187]
    s_add_u32 m0, s72, 58368
    s_add_u32 s34, s86, 24576
    buffer_load_dwordx4 v24, s[20:23], s34 offen lds
    s_waitcnt vmcnt(14)
    s_waitcnt lgkmcnt(0)
    v_mfma_f32_32x32x16_bf16 v[124:139], v[36:39], v[60:63], v[124:139]
    ds_read_b64_tr_b16 v[28:29], v20 offset:0
    ds_read_b64_tr_b16 v[30:31], v20 offset:1024
    buffer_load_dwordx4 v[84:87], v26, s[16:19], s92 offen offset:1024 sc1
    v_mfma_f32_32x32x16_bf16 v[140:155], v[36:39], v[64:67], v[140:155]
    ds_read_b64_tr_b16 v[32:33], v21 offset:0
    ds_read_b64_tr_b16 v[34:35], v21 offset:1024
    buffer_load_dwordx4 v[88:91], v27, s[16:19], s92 offen offset:1024 sc1
    v_mfma_f32_32x32x16_bf16 v[156:171], v[40:43], v[60:63], v[156:171]
    s_add_u32 m0, s72, 65536
    s_add_u32 s34, s86, 32768
    buffer_load_dwordx4 v24, s[20:23], s34 offen lds
    v_mfma_f32_32x32x16_bf16 v[172:187], v[40:43], v[64:67], v[172:187]
    s_add_u32 m0, s72, 66560
    s_add_u32 s34, s86, 40960
    buffer_load_dwordx4 v24, s[20:23], s34 offen lds
    s_waitcnt vmcnt(16)
    s_waitcnt lgkmcnt(0)
    v_mfma_f32_32x32x16_bf16 v[124:139], v[28:31], v[228:231], v[124:139]
    ds_read_b64_tr_b16 v[36:37], v20 offset:8192
    ds_read_b64_tr_b16 v[38:39], v20 offset:9216
    buffer_load_dwordx4 v[188:191], v26, s[16:19], s92 offen offset:2048 sc1
    v_mfma_f32_32x32x16_bf16 v[140:155], v[28:31], v[232:235], v[140:155]
    ds_read_b64_tr_b16 v[40:41], v21 offset:8192
    ds_read_b64_tr_b16 v[42:43], v21 offset:9216
    buffer_load_dwordx4 v[192:195], v27, s[16:19], s92 offen offset:2048 sc1
    v_mfma_f32_32x32x16_bf16 v[156:171], v[32:35], v[228:231], v[156:171]
    s_add_u32 m0, s72, 73728
    s_add_u32 s34, s86, 49152
    buffer_load_dwordx4 v24, s[20:23], s34 offen lds
    v_mfma_f32_32x32x16_bf16 v[172:187], v[32:35], v[232:235], v[172:187]
    s_add_u32 m0, s72, 74752
    s_add_u32 s34, s86, 57344
    buffer_load_dwordx4 v24, s[20:23], s34 offen lds
    s_waitcnt vmcnt(18)
    s_waitcnt lgkmcnt(0)
    v_mfma_f32_32x32x16_bf16 v[124:139], v[36:39], v[68:71], v[124:139]
    ds_read_b64_tr_b16 v[28:29], v20 offset:16384
    ds_read_b64_tr_b16 v[30:31], v20 offset:17408
    buffer_load_dwordx4 v[92:95], v26, s[16:19], s92 offen offset:3072 sc1
    v_mfma_f32_32x32x16_bf16 v[140:155], v[36:39], v[72:75], v[140:155]
    ds_read_b64_tr_b16 v[32:33], v21 offset:16384
    ds_read_b64_tr_b16 v[34:35], v21 offset:17408
    buffer_load_dwordx4 v[96:99], v27, s[16:19], s92 offen offset:3072 sc1
    v_mfma_f32_32x32x16_bf16 v[156:171], v[40:43], v[68:71], v[156:171]
    v_mfma_f32_32x32x16_bf16 v[172:187], v[40:43], v[72:75], v[172:187]
    s_waitcnt vmcnt(18)
    s_waitcnt lgkmcnt(0)
    v_mfma_f32_32x32x16_bf16 v[124:139], v[28:31], v[236:239], v[124:139]
    ds_read_b64_tr_b16 v[36:37], v20 offset:24576
    ds_read_b64_tr_b16 v[38:39], v20 offset:25600
    buffer_load_dwordx4 v[196:199], v26, s[16:19], s93 offen offset:0 sc1
    v_mfma_f32_32x32x16_bf16 v[140:155], v[28:31], v[240:243], v[140:155]
    ds_read_b64_tr_b16 v[40:41], v21 offset:24576
    ds_read_b64_tr_b16 v[42:43], v21 offset:25600
    buffer_load_dwordx4 v[200:203], v27, s[16:19], s93 offen offset:0 sc1
    v_mfma_f32_32x32x16_bf16 v[156:171], v[32:35], v[236:239], v[156:171]
    v_mfma_f32_32x32x16_bf16 v[172:187], v[32:35], v[240:243], v[172:187]
    s_waitcnt vmcnt(18)
    s_waitcnt lgkmcnt(0)
    v_mfma_f32_32x32x16_bf16 v[124:139], v[36:39], v[76:79], v[124:139]
    ds_read_b64_tr_b16 v[28:29], v22 offset:16384
    ds_read_b64_tr_b16 v[30:31], v22 offset:17408
    buffer_load_dwordx4 v[100:103], v26, s[16:19], s93 offen offset:1024 sc1
    v_mfma_f32_32x32x16_bf16 v[140:155], v[36:39], v[80:83], v[140:155]
    ds_read_b64_tr_b16 v[32:33], v23 offset:16384
    ds_read_b64_tr_b16 v[34:35], v23 offset:17408
    buffer_load_dwordx4 v[104:107], v27, s[16:19], s93 offen offset:1024 sc1
    v_mfma_f32_32x32x16_bf16 v[156:171], v[40:43], v[76:79], v[156:171]
    v_mfma_f32_32x32x16_bf16 v[172:187], v[40:43], v[80:83], v[172:187]
    s_waitcnt vmcnt(16)
    s_waitcnt lgkmcnt(0)
    v_mfma_f32_32x32x16_bf16 v[124:139], v[28:31], v[244:247], v[124:139]
    ds_read_b64_tr_b16 v[36:37], v22 offset:24576
    ds_read_b64_tr_b16 v[38:39], v22 offset:25600
    buffer_load_dwordx4 v[204:207], v26, s[16:19], s93 offen offset:2048 sc1
    v_mfma_f32_32x32x16_bf16 v[140:155], v[28:31], v[248:251], v[140:155]
    ds_read_b64_tr_b16 v[40:41], v23 offset:24576
    ds_read_b64_tr_b16 v[42:43], v23 offset:25600
    buffer_load_dwordx4 v[208:211], v27, s[16:19], s93 offen offset:2048 sc1
    v_mfma_f32_32x32x16_bf16 v[156:171], v[32:35], v[244:247], v[156:171]
    v_mfma_f32_32x32x16_bf16 v[172:187], v[32:35], v[248:251], v[172:187]
    s_waitcnt vmcnt(14)
    s_waitcnt lgkmcnt(0)
    v_mfma_f32_32x32x16_bf16 v[124:139], v[36:39], v[84:87], v[124:139]
    ds_read_b64_tr_b16 v[28:29], v20 offset:32768
    ds_read_b64_tr_b16 v[30:31], v20 offset:33792
    buffer_load_dwordx4 v[108:111], v26, s[16:19], s93 offen offset:3072 sc1
    v_mfma_f32_32x32x16_bf16 v[140:155], v[36:39], v[88:91], v[140:155]
    ds_read_b64_tr_b16 v[32:33], v21 offset:32768
    ds_read_b64_tr_b16 v[34:35], v21 offset:33792
    buffer_load_dwordx4 v[112:115], v27, s[16:19], s93 offen offset:3072 sc1
    v_mfma_f32_32x32x16_bf16 v[156:171], v[40:43], v[84:87], v[156:171]
    v_mfma_f32_32x32x16_bf16 v[172:187], v[40:43], v[88:91], v[172:187]
    s_waitcnt vmcnt(22)
    s_waitcnt vmcnt(18)
    s_waitcnt vmcnt(12)
    s_waitcnt lgkmcnt(0)
    v_mfma_f32_32x32x16_bf16 v[124:139], v[28:31], v[188:191], v[124:139]
    ds_read_b64_tr_b16 v[36:37], v20 offset:40960
    ds_read_b64_tr_b16 v[38:39], v20 offset:41984
    ds_read_b64_tr_b16 v[40:41], v21 offset:40960
    v_mfma_f32_32x32x16_bf16 v[140:155], v[28:31], v[192:195], v[140:155]
    ds_read_b64_tr_b16 v[42:43], v21 offset:41984
    ds_read_b64_tr_b16 v[44:45], v20 offset:49152
    ds_read_b64_tr_b16 v[46:47], v20 offset:50176
    v_mfma_f32_32x32x16_bf16 v[156:171], v[32:35], v[188:191], v[156:171]
    ds_read_b64_tr_b16 v[48:49], v21 offset:49152
    ds_read_b64_tr_b16 v[50:51], v21 offset:50176
    ds_read_b64_tr_b16 v[116:117], v20 offset:57344
    v_mfma_f32_32x32x16_bf16 v[172:187], v[32:35], v[192:195], v[172:187]
    ds_read_b64_tr_b16 v[118:119], v20 offset:58368
    ds_read_b64_tr_b16 v[120:121], v21 offset:57344
    ds_read_b64_tr_b16 v[122:123], v21 offset:58368
    s_waitcnt vmcnt(14)
    s_waitcnt vmcnt(10)
    s_waitcnt vmcnt(8)
    s_waitcnt lgkmcnt(8)
    v_mfma_f32_32x32x16_bf16 v[124:139], v[36:39], v[92:95], v[124:139]
    ds_read_b64_tr_b16 v[212:213], v22 offset:0
    ds_read_b64_tr_b16 v[214:215], v22 offset:1024
    v_mfma_f32_32x32x16_bf16 v[140:155], v[36:39], v[96:99], v[140:155]
    ds_read_b64_tr_b16 v[216:217], v23 offset:0
    ds_read_b64_tr_b16 v[218:219], v23 offset:1024
    v_mfma_f32_32x32x16_bf16 v[156:171], v[40:43], v[92:95], v[156:171]
    ds_read_b64_tr_b16 v[52:53], v22 offset:8192
    ds_read_b64_tr_b16 v[54:55], v22 offset:9216
    v_mfma_f32_32x32x16_bf16 v[172:187], v[40:43], v[96:99], v[172:187]
    ds_read_b64_tr_b16 v[56:57], v23 offset:8192
    ds_read_b64_tr_b16 v[58:59], v23 offset:9216
    v_add_u32 v2, s72, v17
    s_waitcnt vmcnt(0)
    s_waitcnt lgkmcnt(0)
    v_mfma_f32_32x32x16_bf16 v[172:187], v[48:51], v[200:203], v[172:187]
    s_mov_b32 s34, 10485760
    buffer_load_dwordx2 v[220:221], v254, s[16:19], s34 offen sc1
    v_xor_b32 v21, 2048, v2
    v_mfma_f32_32x32x16_bf16 v[172:187], v[120:123], v[104:107], v[172:187]
    s_mov_b32 s34, 10502144
    buffer_load_dwordx2 v[222:223], v254, s[16:19], s34 offen sc1
    v_xor_b32 v22, 4096, v2
    v_mfma_f32_32x32x16_bf16 v[172:187], v[216:219], v[208:211], v[172:187]
    s_mov_b32 s34, 10551296
    buffer_load_dwordx2 v[224:225], v254, s[16:19], s34 offen sc1
    v_xor_b32 v23, 6144, v2
    v_mfma_f32_32x32x16_bf16 v[172:187], v[56:59], v[112:115], v[172:187]
    s_mov_b32 s34, 10567680
    buffer_load_dwordx2 v[226:227], v254, s[16:19], s34 offen sc1
    v_mfma_f32_32x32x16_bf16 v[156:171], v[48:51], v[196:199], v[156:171]
    s_mov_b32 s34, 10616832
    buffer_load_dwordx2 v[60:61], v254, s[16:19], s34 offen sc1
    v_mfma_f32_32x32x16_bf16 v[156:171], v[120:123], v[100:103], v[156:171]
    s_mov_b32 s34, 10633216
    buffer_load_dwordx2 v[62:63], v254, s[16:19], s34 offen sc1
    s_nop 3
    ds_write_b128 v2, v[172:175] offset:32768
    v_mfma_f32_32x32x16_bf16 v[156:171], v[216:219], v[204:207], v[156:171]
    s_mov_b32 s34, 10682368
    buffer_load_dwordx2 v[64:65], v254, s[16:19], s34 offen sc1
    ds_write_b128 v2, v[176:179] offset:33792
    v_mfma_f32_32x32x16_bf16 v[156:171], v[56:59], v[108:111], v[156:171]
    s_mov_b32 s34, 10698752
    buffer_load_dwordx2 v[66:67], v254, s[16:19], s34 offen sc1
    ds_write_b128 v2, v[180:183] offset:40960
    ds_write_b128 v2, v[184:187] offset:41984
    v_mfma_f32_32x32x16_bf16 v[140:155], v[44:47], v[200:203], v[140:155]
    buffer_load_dwordx2 v[18:19], v255, s[16:19], s69 offen sc1
    v_mfma_f32_32x32x16_bf16 v[140:155], v[116:119], v[104:107], v[140:155]
    s_nop 4
    ds_write_b128 v2, v[156:159] offset:16384
    v_mfma_f32_32x32x16_bf16 v[140:155], v[212:215], v[208:211], v[140:155]
    ds_write_b128 v2, v[160:163] offset:17408
    v_mfma_f32_32x32x16_bf16 v[140:155], v[52:55], v[112:115], v[140:155]
    ds_write_b128 v2, v[164:167] offset:24576
    ds_write_b128 v2, v[168:171] offset:25600
    v_mfma_f32_32x32x16_bf16 v[124:139], v[44:47], v[196:199], v[124:139]
    v_mfma_f32_32x32x16_bf16 v[124:139], v[116:119], v[100:103], v[124:139]
    s_nop 7
    ds_write_b128 v2, v[140:143] offset:0
    v_mfma_f32_32x32x16_bf16 v[124:139], v[212:215], v[204:207], v[124:139]
    ds_write_b128 v2, v[144:147] offset:1024
    v_mfma_f32_32x32x16_bf16 v[124:139], v[52:55], v[108:111], v[124:139]
    ds_write_b128 v2, v[148:151] offset:8192
    ds_write_b128 v2, v[152:155] offset:9216
    v_lshrrev_b32 v3, 5, v1
    v_lshl_add_u32 v253, v3, 3, v253
    s_waitcnt lgkmcnt(0)
    s_barrier
    ds_read_b128 v[236:239], v21 offset:0
    ds_read_b128 v[240:243], v21 offset:1024
    ds_read_b128 v[76:79], v21 offset:8192
    ds_read_b128 v[80:83], v21 offset:9216
    ds_read_b128 v[244:247], v22 offset:16384
    ds_read_b128 v[248:251], v22 offset:17408
    ds_read_b128 v[84:87], v22 offset:24576
    ds_read_b128 v[88:91], v22 offset:25600
    ds_read_b128 v[188:191], v23 offset:32768
    ds_read_b128 v[192:195], v23 offset:33792
    ds_read_b128 v[92:95], v23 offset:40960
    ds_read_b128 v[96:99], v23 offset:41984
    s_mov_b32 s75, 0
C_y:
    s_waitcnt vmcnt(0)
    v_xor_b32 v14, s68, v19
    v_xor_b32 v15, s68, v221
    v_xor_b32 v10, s68, v223
    v_or3_b32 v14, v14, v15, v10
    v_xor_b32 v15, s68, v225
    v_xor_b32 v10, s68, v227
    v_or3_b32 v14, v14, v15, v10
    v_xor_b32 v15, s68, v61
    v_xor_b32 v10, s68, v63
    v_or3_b32 v14, v14, v15, v10
    v_xor_b32 v15, s68, v65
    v_xor_b32 v10, s68, v67
    v_or3_b32 v14, v14, v15, v10
    v_cmp_ne_u32 vcc, 0, v14
    s_add_u32 s75, s75, 1
    s_cbranch_vccz C_y_ok
    s_sleep 2
    s_mov_b32 s34, 10485760
    buffer_load_dwordx2 v[220:221], v254, s[16:19], s34 offen sc1
    s_mov_b32 s34, 10502144
    buffer_load_dwordx2 v[222:223], v254, s[16:19], s34 offen sc1
    s_mov_b32 s34, 10551296
    buffer_load_dwordx2 v[224:225], v254, s[16:19], s34 offen sc1
    s_mov_b32 s34, 10567680
    buffer_load_dwordx2 v[226:227], v254, s[16:19], s34 offen sc1
    s_mov_b32 s34, 10616832
    buffer_load_dwordx2 v[60:61], v254, s[16:19], s34 offen sc1
    s_mov_b32 s34, 10633216
    buffer_load_dwordx2 v[62:63], v254, s[16:19], s34 offen sc1
    s_mov_b32 s34, 10682368
    buffer_load_dwordx2 v[64:65], v254, s[16:19], s34 offen sc1
    s_mov_b32 s34, 10698752
    buffer_load_dwordx2 v[66:67], v254, s[16:19], s34 offen sc1
    buffer_load_dwordx2 v[18:19], v255, s[16:19], s69 offen sc1
    s_cmp_lt_u32 s75, 131072
    s_cbranch_scc1 C_y
C_y_ok:
    v_sub_f32 v4, 1.0, v18
    v_mov_b32 v19, v18
    v_cvt_pk_bf16_f32 v4, v4, v4
    v_lshlrev_b32 v4, 16, v4
    v_lshlrev_b32 v228, 16, v220
    v_and_b32 v229, 0xffff0000, v220
    v_pk_mul_f32 v[228:229], v[228:229], v[18:19]
    v_lshlrev_b32 v230, 16, v222
    v_and_b32 v231, 0xffff0000, v222
    v_pk_mul_f32 v[230:231], v[230:231], v[18:19]
    v_lshlrev_b32 v232, 16, v224
    v_and_b32 v233, 0xffff0000, v224
    v_pk_mul_f32 v[232:233], v[232:233], v[18:19]
    v_lshlrev_b32 v234, 16, v226
    v_and_b32 v235, 0xffff0000, v226
    v_pk_mul_f32 v[234:235], v[234:235], v[18:19]
    v_lshlrev_b32 v68, 16, v60
    v_and_b32 v69, 0xffff0000, v60
    v_pk_mul_f32 v[68:69], v[68:69], v[18:19]
    v_lshlrev_b32 v70, 16, v62
    v_and_b32 v71, 0xffff0000, v62
    v_pk_mul_f32 v[70:71], v[70:71], v[18:19]
    v_lshlrev_b32 v72, 16, v64
    v_and_b32 v73, 0xffff0000, v64
    v_pk_mul_f32 v[72:73], v[72:73], v[18:19]
    v_lshlrev_b32 v74, 16, v66
    v_and_b32 v75, 0xffff0000, v66
    v_pk_mul_f32 v[74:75], v[74:75], v[18:19]
    v_mov_b32 v18, v4
    v_mov_b32 v19, v4
    s_waitcnt lgkmcnt(8)
    v_pk_add_f32 v[124:125], v[124:125], v[236:237]
    v_pk_add_f32 v[126:127], v[126:127], v[238:239]
    v_pk_add_f32 v[128:129], v[128:129], v[240:241]
    v_pk_add_f32 v[130:131], v[130:131], v[242:243]
    v_pk_add_f32 v[132:133], v[132:133], v[76:77]
    v_pk_add_f32 v[134:135], v[134:135], v[78:79]
    v_pk_add_f32 v[136:137], v[136:137], v[80:81]
    v_pk_add_f32 v[138:139], v[138:139], v[82:83]
    s_waitcnt lgkmcnt(4)
    v_pk_add_f32 v[124:125], v[124:125], v[244:245]
    v_pk_add_f32 v[126:127], v[126:127], v[246:247]
    v_pk_add_f32 v[128:129], v[128:129], v[248:249]
    v_pk_add_f32 v[130:131], v[130:131], v[250:251]
    v_pk_add_f32 v[132:133], v[132:133], v[84:85]
    v_pk_add_f32 v[134:135], v[134:135], v[86:87]
    v_pk_add_f32 v[136:137], v[136:137], v[88:89]
    v_pk_add_f32 v[138:139], v[138:139], v[90:91]
    s_waitcnt lgkmcnt(0)
    v_pk_add_f32 v[124:125], v[124:125], v[188:189]
    v_pk_add_f32 v[126:127], v[126:127], v[190:191]
    v_pk_add_f32 v[128:129], v[128:129], v[192:193]
    v_pk_add_f32 v[130:131], v[130:131], v[194:195]
    v_pk_add_f32 v[132:133], v[132:133], v[92:93]
    v_pk_add_f32 v[134:135], v[134:135], v[94:95]
    v_pk_add_f32 v[136:137], v[136:137], v[96:97]
    v_pk_add_f32 v[138:139], v[138:139], v[98:99]
    v_pk_fma_f32 v[124:125], v[124:125], v[18:19], v[228:229]
    v_pk_fma_f32 v[126:127], v[126:127], v[18:19], v[230:231]
    v_pk_fma_f32 v[128:129], v[128:129], v[18:19], v[232:233]
    v_pk_fma_f32 v[130:131], v[130:131], v[18:19], v[234:235]
    v_pk_fma_f32 v[132:133], v[132:133], v[18:19], v[68:69]
    v_pk_fma_f32 v[134:135], v[134:135], v[18:19], v[70:71]
    v_pk_fma_f32 v[136:137], v[136:137], v[18:19], v[72:73]
    v_pk_fma_f32 v[138:139], v[138:139], v[18:19], v[74:75]
    v_cvt_pk_bf16_f32 v140, v124, v125
    v_cvt_pk_bf16_f32 v141, v126, v127
    v_cvt_pk_bf16_f32 v142, v128, v129
    v_cvt_pk_bf16_f32 v143, v130, v131
    v_cvt_pk_bf16_f32 v144, v132, v133
    v_cvt_pk_bf16_f32 v145, v134, v135
    v_cvt_pk_bf16_f32 v146, v136, v137
    v_cvt_pk_bf16_f32 v147, v138, v139
    v_permlane32_swap_b32 v140, v142
    v_permlane32_swap_b32 v141, v143
    buffer_store_dwordx4 v[140:143], v253, s[24:27], 0 offen offset:0
    v_permlane32_swap_b32 v144, v146
    v_permlane32_swap_b32 v145, v147
    buffer_store_dwordx4 v[144:147], v253, s[24:27], 0 offen offset:32
    s_endpgm
C_aux:
    s_setprio 0
    s_waitcnt lgkmcnt(0)
    s_barrier
    v_bfe_u32 v2, v1, 2, 2
    v_lshrrev_b32 v3, 5, v1
    v_lshl_add_u32 v3, v3, 2, v2
    v_lshlrev_b32 v3, 7, v3
    v_lshrrev_b32 v2, 1, v2
    s_lshr_b32 s34, s28, 1
    v_xor_b32 v2, s34, v2
    v_lshl_add_u32 v3, v2, 6, v3
    v_bfe_u32 v2, v1, 4, 1
    v_lshl_add_u32 v3, v2, 5, v3
    v_and_b32 v2, 3, v1
    v_lshl_add_u32 v3, v2, 3, v3
    s_lshl_b32 s72, s28, 11
    v_add_u32 v20, s72, v3
    v_xor_b32 v21, 64, v20
    v_add_u32 v22, 0x10000, v20
    v_add_u32 v23, 0x10000, v21
    s_and_b32 s34, s28, 1
    s_mul_i32 s34, s34, 114688
    v_add_u32 v26, s34, v17
    s_sub_u32 s34, 114688, s34
    v_add_u32 v27, s34, v17
    v_bfe_u32 v2, v1, 4, 1
    v_lshlrev_b32 v2, 2, v2
    v_xor_b32 v2, v2, v1
    v_and_b32 v2, 7, v2
    v_lshlrev_b32 v2, 4, v2
    v_lshrrev_b32 v24, 3, v1
    v_lshl_add_u32 v24, v24, 10, v2
    s_mul_i32 s34, s28, 458752
    s_lshl_b32 s35, s33, 7
    s_add_u32 s34, s34, s35
    s_and_b32 s35, s32, 3
    s_lshl_b32 s35, s35, 1
    s_add_u32 s35, s35, s33
    s_cmp_ge_u32 s35, 7
    s_cselect_b32 s80, 7, 0
    s_sub_u32 s35, s35, s80
    s_lshl_b32 s35, s35, 12
    s_mul_i32 s78, s32, 229376
    s_mul_i32 s79, s28, 28672
    s_add_u32 s78, s78, s79
    s_lshl_b32 s80, s35, 4
    s_add_u32 s80, s80, s34
    s_add_u32 s87, s78, s35
    s_add_u32 s35, s35, 4096
    s_cmp_eq_u32 s35, 28672
    s_cselect_b32 s35, 0, s35
    s_lshl_b32 s81, s35, 4
    s_add_u32 s81, s81, s34
    s_add_u32 s88, s78, s35
    s_add_u32 s35, s35, 4096
    s_cmp_eq_u32 s35, 28672
    s_cselect_b32 s35, 0, s35
    s_lshl_b32 s82, s35, 4
    s_add_u32 s82, s82, s34
    s_add_u32 s89, s78, s35
    s_add_u32 s35, s35, 4096
    s_cmp_eq_u32 s35, 28672
    s_cselect_b32 s35, 0, s35
    s_lshl_b32 s83, s35, 4
    s_add_u32 s83, s83, s34
    s_add_u32 s90, s78, s35
    s_add_u32 s35, s35, 4096
    s_cmp_eq_u32 s35, 28672
    s_cselect_b32 s35, 0, s35
    s_lshl_b32 s84, s35, 4
    s_add_u32 s84, s84, s34
    s_add_u32 s91, s78, s35
    s_add_u32 s35, s35, 4096
    s_cmp_eq_u32 s35, 28672
    s_cselect_b32 s35, 0, s35
    s_lshl_b32 s85, s35, 4
    s_add_u32 s85, s85, s34
    s_add_u32 s92, s78, s35
    s_add_u32 s35, s35, 4096
    s_cmp_eq_u32 s35, 28672
    s_cselect_b32 s35, 0, s35
    s_lshl_b32 s86, s35, 4
    s_add_u32 s86, s86, s34
    s_add_u32 s93, s78, s35
    s_mov_b32 s20, s60
    s_mov_b32 s21, s61
    s_mov_b32 s22, 1835008
    s_mov_b32 s23, 0x20000
    s_mov_b32 s24, s64
    s_mov_b32 s25, s65
    s_mov_b32 s26, 2097152
    s_mov_b32 s27, 0x20000
    s_mul_i32 s95, s32, 28
    s_mul_i32 s34, s28, 7
    s_add_u32 s95, s95, s34
    s_lshl_b32 s95, s95, 7
    s_add_u32 s95, s95, 15728640
    s_and_b32 s34, s28, 1
    s_lshl_b32 s34, s34, 5
    s_lshl_b32 s35, s32, 6
    s_add_u32 s34, s34, s35
    v_and_b32 v2, 31, v1
    v_add_u32 v2, s34, v2
    v_lshrrev_b32 v3, 5, v1
    s_lshr_b32 s34, s28, 1
    s_lshl_b32 s34, s34, 6
    s_lshl_b32 s35, s33, 7
    s_add_u32 s34, s34, s35
    v_lshlrev_b32 v4, 3, v3
    v_add_u32 v4, s34, v4
    v_lshl_add_u32 v253, v2, 10, v4
    v_lshlrev_b32 v255, 3, v2
    v_lshrrev_b32 v3, 8, v2
    v_lshlrev_b32 v254, 11, v3
    v_bfe_u32 v3, v2, 1, 1
    v_lshl_add_u32 v254, v3, 10, v254
    v_bfe_u32 v3, v2, 2, 6
    v_lshl_add_u32 v254, v3, 4, v254
    v_and_b32 v3, 1, v2
    v_lshl_add_u32 v254, v3, 3, v254
    v_lshl_add_u32 v254, v4, 12, v254
    s_and_b32 s34, s28, 1
    s_lshl_b32 s34, s34, 1
    s_lshl_b32 s35, s29, 2
    s_add_u32 s34, s34, s35
    s_mul_i32 s34, s34, 112
    s_lshl_b32 s35, s30, 3
    s_add_u32 s34, s34, s35
    s_and_b32 s35, s28, 2
    s_lshl_b32 s35, s35, 1
    s_add_u32 s34, s34, s35
    s_lshl_b32 s73, s34, 10
    s_add_u32 s74, s73, 114688
    s_lshr_b32 s71, s28, 1
    s_lshl_b32 s35, s30, 1
    s_add_u32 s71, s71, s35
    s_and_b32 s34, s28, 1
    s_lshl_b32 s35, s29, 1
    s_add_u32 s34, s34, s35
    s_mul_i32 s34, s34, 28
    s_add_u32 s71, s71, s34
    s_lshl_b32 s71, s71, 7
    s_add_u32 s71, s71, 15728640
    s_mov_b32 s78, 3216550459
    s_mov_b32 s79, 3216550459
    s_add_u32 s34, s2, s28
    s_add_u32 s34, s34, 0
    s_and_b32 s34, s34, 7
    s_mul_i32 s34, s34, 28
    s_lshr_b32 s96, s2, 3
    s_add_u32 s96, s96, s34
    s_and_b32 s34, s28, 0
    s_xor_b32 s96, s96, s34
    s_lshl_b32 s96, s96, 13
    global_load_dword v5, v25, s[66:67] sc1
    s_mov_b64 exec, 1
    ds_add_u32 v7, v8 offset:12
    s_mov_b64 exec, -1
    s_waitcnt vmcnt(0)
    v_mov_b32 v4, 0
    s_mov_b32 s75, 0
Ltok12:
    v_readfirstlane_b32 s68, v5
    s_add_u32 s75, s75, 1
    s_cmp_lg_u32 s68, 0
    s_cbranch_scc1 Ltok12_ok
    global_load_dword v5, v4, s[66:67] sc1
    s_waitcnt vmcnt(0)
    s_cmp_lt_u32 s75, 131072
    s_cbranch_scc1 Ltok12
Ltok12_ok:
    s_mov_b32 s75, 0
Llw13:
    ds_read_b32 v2, v7 offset:0
    s_add_u32 s75, s75, 1
    s_waitcnt lgkmcnt(0)
    v_readfirstlane_b32 s34, v2
    s_nop 0
    s_cmp_ge_u32 s34, 4
    s_cbranch_scc1 Llw13_ok
    s_sleep 0
    s_cmp_lt_u32 s75, 2097152
    s_cbranch_scc1 Llw13
Llw13_ok:
    ds_read_b64_tr_b16 v[28:29], v22 offset:49152
    ds_read_b64_tr_b16 v[30:31], v22 offset:50176
    ds_read_b64_tr_b16 v[32:33], v23 offset:49152
    ds_read_b64_tr_b16 v[34:35], v23 offset:50176
    ds_read_b64_tr_b16 v[36:37], v22 offset:57344
    ds_read_b64_tr_b16 v[38:39], v22 offset:58368
    ds_read_b64_tr_b16 v[40:41], v23 offset:57344
    ds_read_b64_tr_b16 v[42:43], v23 offset:58368
    s_mov_b64 exec, 1
    ds_add_u32 v7, v8 offset:8
    s_mov_b64 exec, -1
    ds_read_b64_tr_b16 v[44:45], v22 offset:0
    ds_read_b64_tr_b16 v[46:47], v22 offset:1024
    ds_read_b64_tr_b16 v[48:49], v23 offset:0
    ds_read_b64_tr_b16 v[50:51], v23 offset:1024
    ds_read_b64_tr_b16 v[52:53], v22 offset:8192
    ds_read_b64_tr_b16 v[54:55], v22 offset:9216
    ds_read_b64_tr_b16 v[56:57], v23 offset:8192
    ds_read_b64_tr_b16 v[58:59], v23 offset:9216
    s_waitcnt lgkmcnt(6)
    ds_read_b64_tr_b16 v[60:61], v20 offset:0
    ds_read_b64_tr_b16 v[62:63], v20 offset:1024
    ds_read_b64_tr_b16 v[64:65], v21 offset:0
    ds_read_b64_tr_b16 v[66:67], v21 offset:1024
    ds_read_b64_tr_b16 v[68:69], v20 offset:8192
    ds_read_b64_tr_b16 v[70:71], v20 offset:9216
    ds_read_b64_tr_b16 v[72:73], v21 offset:8192
    ds_read_b64_tr_b16 v[74:75], v21 offset:9216
    s_waitcnt lgkmcnt(6)
    ds_read_b64_tr_b16 v[76:77], v20 offset:16384
    ds_read_b64_tr_b16 v[78:79], v20 offset:17408
    ds_read_b64_tr_b16 v[80:81], v21 offset:16384
    ds_read_b64_tr_b16 v[82:83], v21 offset:17408
    ds_read_b64_tr_b16 v[84:85], v20 offset:24576
    ds_read_b64_tr_b16 v[86:87], v20 offset:25600
    ds_read_b64_tr_b16 v[88:89], v21 offset:24576
    ds_read_b64_tr_b16 v[90:91], v21 offset:25600
    s_waitcnt lgkmcnt(6)
    ds_read_b64_tr_b16 v[92:93], v22 offset:16384
    ds_read_b64_tr_b16 v[94:95], v22 offset:17408
    ds_read_b64_tr_b16 v[96:97], v23 offset:16384
    ds_read_b64_tr_b16 v[98:99], v23 offset:17408
    ds_read_b64_tr_b16 v[100:101], v22 offset:24576
    ds_read_b64_tr_b16 v[102:103], v22 offset:25600
    ds_read_b64_tr_b16 v[104:105], v23 offset:24576
    ds_read_b64_tr_b16 v[106:107], v23 offset:25600
    s_waitcnt lgkmcnt(6)
    ds_read_b64_tr_b16 v[108:109], v20 offset:32768
    ds_read_b64_tr_b16 v[110:111], v20 offset:33792
    ds_read_b64_tr_b16 v[112:113], v21 offset:32768
    ds_read_b64_tr_b16 v[114:115], v21 offset:33792
    ds_read_b64_tr_b16 v[116:117], v20 offset:40960
    ds_read_b64_tr_b16 v[118:119], v20 offset:41984
    ds_read_b64_tr_b16 v[120:121], v21 offset:40960
    ds_read_b64_tr_b16 v[122:123], v21 offset:41984
    s_waitcnt lgkmcnt(6)
    s_setprio 2
    s_branch C_p2
L_role:
    s_sub_u32 s69, s28, 4
    v_mov_b32 v13, 0
    s_cmp_lg_u32 s31, 0
    s_cbranch_scc1 L_aux
    s_lshl_b32 s70, s29, 17
    s_lshl_b32 s71, s30, 8
    s_lshl_b32 s72, s69, 10
    v_lshrrev_b32 v2, 4, v1
    s_lshl_b32 s34, s69, 2
    v_add_u32 v3, s34, v2
    v_xor_b32 v4, v3, v1
    v_and_b32 v4, 7, v4
    v_lshlrev_b32 v4, 4, v4
    v_bfe_u32 v9, v0, 3, 5
    v_lshl_add_u32 v9, v9, 10, v4
    v_mul_u32_u24 v10, 3584, v3
    v_lshlrev_b32 v2, 2, v2
    v_xor_b32 v2, v2, v1
    v_and_b32 v2, 15, v2
    v_lshl_add_u32 v10, v2, 4, v10
    s_bfe_u32 s35, s2, 0x20001
    s_mul_i32 s35, s30, 2
    s_add_u32 s35, s35, s29
    s_and_b32 s35, s35, 7
    s_waitcnt lgkmcnt(0)
    s_mul_i32 s87, s35, 229376
    s_add_u32 s87, s87, s71
    s_lshl_b32 s38, s35, 7
    s_add_u32 s38, s38, s70
    s_add_u32 s35, s35, 1
    s_and_b32 s35, s35, 7
    s_mul_i32 s88, s35, 229376
    s_add_u32 s88, s88, s71
    s_lshl_b32 s39, s35, 7
    s_add_u32 s39, s39, s70
    s_add_u32 s35, s35, 1
    s_and_b32 s35, s35, 7
    s_mul_i32 s89, s35, 229376
    s_add_u32 s89, s89, s71
    s_lshl_b32 s40, s35, 7
    s_add_u32 s40, s40, s70
    s_add_u32 s35, s35, 1
    s_and_b32 s35, s35, 7
    s_mov_b32 s4, s36
    s_mov_b32 s5, s37
    s_mov_b32 s6, 2097152
    s_mov_b32 s7, 0x20000
    s_mov_b32 s8, s56
    s_mov_b32 s9, s57
    s_mov_b32 s10, 1835008
    s_mov_b32 s11, 0x20000
    s_mov_b32 s12, s58
    s_mov_b32 s13, s59
    s_mov_b32 s14, 1835008
    s_mov_b32 s15, 0x20000
    s_add_u32 m0, s72, 81920
    s_add_u32 s34, s38, 0
    buffer_load_dwordx4 v9, s[4:7], s34 offen lds
    s_add_u32 m0, s72, 86016
    s_add_u32 s34, s38, 32768
    buffer_load_dwordx4 v9, s[4:7], s34 offen lds
    s_add_u32 m0, s72, 90112
    s_add_u32 s34, s38, 65536
    buffer_load_dwordx4 v9, s[4:7], s34 offen lds
    s_add_u32 m0, s72, 94208
    s_add_u32 s34, s38, 98304
    buffer_load_dwordx4 v9, s[4:7], s34 offen lds
    s_add_u32 m0, s72, 0
    s_add_u32 s34, s87, 0
    buffer_load_dwordx4 v10, s[8:11], s34 offen lds
    s_add_u32 m0, s72, 8192
    s_add_u32 s34, s87, 0
    buffer_load_dwordx4 v10, s[12:15], s34 offen lds
    s_add_u32 m0, s72, 4096
    s_add_u32 s34, s87, 57344
    buffer_load_dwordx4 v10, s[8:11], s34 offen lds
    s_add_u32 m0, s72, 12288
    s_add_u32 s34, s87, 57344
    buffer_load_dwordx4 v10, s[12:15], s34 offen lds
    s_add_u32 m0, s72, 16384
    s_add_u32 s34, s87, 114688
    buffer_load_dwordx4 v10, s[8:11], s34 offen lds
    s_add_u32 m0, s72, 24576
    s_add_u32 s34, s87, 114688
    buffer_load_dwordx4 v10, s[12:15], s34 offen lds
    s_add_u32 m0, s72, 20480
    s_add_u32 s34, s87, 172032
    buffer_load_dwordx4 v10, s[8:11], s34 offen lds
    s_add_u32 m0, s72, 28672
    s_add_u32 s34, s87, 172032
    buffer_load_dwordx4 v10, s[12:15], s34 offen lds
    s_mul_i32 s90, s35, 229376
    s_add_u32 s90, s90, s71
    s_lshl_b32 s41, s35, 7
    s_add_u32 s41, s41, s70
    s_add_u32 s35, s35, 1
    s_and_b32 s35, s35, 7
    s_mul_i32 s91, s35, 229376
    s_add_u32 s91, s91, s71
    s_lshl_b32 s42, s35, 7
    s_add_u32 s42, s42, s70
    s_add_u32 s35, s35, 1
    s_and_b32 s35, s35, 7
    s_mul_i32 s92, s35, 229376
    s_add_u32 s92, s92, s71
    s_lshl_b32 s43, s35, 7
    s_add_u32 s43, s43, s70
    s_add_u32 s35, s35, 1
    s_and_b32 s35, s35, 7
    s_mul_i32 s93, s35, 229376
    s_add_u32 s93, s93, s71
    s_lshl_b32 s44, s35, 7
    s_add_u32 s44, s44, s70
    s_add_u32 s35, s35, 1
    s_and_b32 s35, s35, 7
    s_mul_i32 s94, s35, 229376
    s_add_u32 s94, s94, s71
    s_lshl_b32 s45, s35, 7
    s_add_u32 s45, s45, s70
    s_add_u32 s35, s35, 1
    s_and_b32 s35, s35, 7
    s_mov_b32 s20, s60
    s_mov_b32 s21, s61
    s_mov_b32 s22, 1835008
    s_mov_b32 s23, 0x20000
    v_bfe_u32 v2, v1, 4, 1
    v_lshlrev_b32 v2, 2, v2
    v_xor_b32 v2, v2, v1
    v_and_b32 v2, 7, v2
    v_lshlrev_b32 v2, 4, v2
    v_lshrrev_b32 v11, 3, v1
    v_lshl_add_u32 v11, v11, 10, v2
    s_mul_i32 s34, s69, 458752
    s_lshl_b32 s35, s33, 7
    s_add_u32 s34, s34, s35
    s_and_b32 s35, s32, 3
    s_lshl_b32 s35, s35, 1
    s_add_u32 s35, s35, s33
    s_cmp_ge_u32 s35, 7
    s_cselect_b32 s80, 7, 0
    s_sub_u32 s35, s35, s80
    s_lshl_b32 s35, s35, 12
    s_lshl_b32 s80, s35, 4
    s_add_u32 s80, s80, s34
    s_add_u32 s35, s35, 4096
    s_cmp_eq_u32 s35, 28672
    s_cselect_b32 s35, 0, s35
    s_lshl_b32 s81, s35, 4
    s_add_u32 s81, s81, s34
    s_add_u32 s35, s35, 4096
    s_cmp_eq_u32 s35, 28672
    s_cselect_b32 s35, 0, s35
    s_lshl_b32 s82, s35, 4
    s_add_u32 s82, s82, s34
    s_add_u32 s35, s35, 4096
    s_cmp_eq_u32 s35, 28672
    s_cselect_b32 s35, 0, s35
    s_lshl_b32 s83, s35, 4
    s_add_u32 s83, s83, s34
    s_add_u32 s35, s35, 4096
    s_cmp_eq_u32 s35, 28672
    s_cselect_b32 s35, 0, s35
    s_lshl_b32 s84, s35, 4
    s_add_u32 s84, s84, s34
    s_add_u32 s35, s35, 4096
    s_cmp_eq_u32 s35, 28672
    s_cselect_b32 s35, 0, s35
    s_lshl_b32 s85, s35, 4
    s_add_u32 s85, s85, s34
    s_add_u32 s35, s35, 4096
    s_cmp_eq_u32 s35, 28672
    s_cselect_b32 s35, 0, s35
    s_lshl_b32 s86, s35, 4
    s_add_u32 s86, s86, s34
    s_lshl_b32 s73, s69, 11
    v_lshlrev_b32 v15, 2, v1
    s_lshr_b32 s74, s2, 6
    s_lshl_b32 s74, s74, 7
    s_add_u32 s74, s74, 16252928
    v_lshrrev_b32 v16, 1, v1
    v_lshlrev_b32 v16, 16, v16
    v_and_b32 v2, 1, v1
    v_lshl_add_u32 v16, v2, 4, v16
    v_and_b32 v17, 15, v1
    v_lshrrev_b32 v18, 4, v1
    s_and_b32 s35, s69, 2
    s_mul_i32 s35, s35, 4160
    s_add_u32 s35, s35, 132320
    v_and_b32 v2, 3, v1
    v_bfe_u32 v4, v1, 2, 2
    v_sub_u32 v2, v2, v4
    v_lshlrev_b32 v4, 3, v18
    v_sub_u32 v2, v2, v4
    v_lshlrev_b32 v2, 3, v2
    v_add_u32 v19, s35, v2
    s_mul_i32 s78, s69, 2304
    s_add_u32 s35, s78, 148744
    v_lshlrev_b32 v2, 3, v17
    v_lshl_add_u32 v2, v18, 4, v2
    v_add_u32 v20, s35, v2
    s_lshl_b32 s79, s2, 8
    s_and_b32 s35, s69, 1
    s_lshl_b32 s35, s35, 7
    s_add_u32 s79, s79, s35
    s_and_b32 s35, s69, 2
    s_lshl_b32 s35, s35, 5
    s_add_u32 s79, s79, s35
    s_barrier
    s_add_u32 m0, s72, 98304
    s_add_u32 s34, s39, 0
    buffer_load_dwordx4 v9, s[4:7], s34 offen lds
    s_add_u32 m0, s72, 102400
    s_add_u32 s34, s39, 32768
    buffer_load_dwordx4 v9, s[4:7], s34 offen lds
    s_add_u32 m0, s72, 106496
    s_add_u32 s34, s39, 65536
    buffer_load_dwordx4 v9, s[4:7], s34 offen lds
    s_add_u32 m0, s72, 110592
    s_add_u32 s34, s39, 98304
    buffer_load_dwordx4 v9, s[4:7], s34 offen lds
    s_waitcnt vmcnt(8)
    s_barrier
    s_add_u32 m0, s72, 32768
    s_add_u32 s34, s88, 0
    buffer_load_dwordx4 v10, s[8:11], s34 offen lds
    s_add_u32 m0, s72, 40960
    s_add_u32 s34, s88, 0
    buffer_load_dwordx4 v10, s[12:15], s34 offen lds
    s_add_u32 m0, s72, 36864
    s_add_u32 s34, s88, 57344
    buffer_load_dwordx4 v10, s[8:11], s34 offen lds
    s_add_u32 m0, s72, 45056
    s_add_u32 s34, s88, 57344
    buffer_load_dwordx4 v10, s[12:15], s34 offen lds
    s_add_u32 m0, s72, 49152
    s_add_u32 s34, s88, 114688
    buffer_load_dwordx4 v10, s[8:11], s34 offen lds
    s_add_u32 m0, s72, 57344
    s_add_u32 s34, s88, 114688
    buffer_load_dwordx4 v10, s[12:15], s34 offen lds
    s_add_u32 m0, s72, 53248
    s_add_u32 s34, s88, 172032
    buffer_load_dwordx4 v10, s[8:11], s34 offen lds
    s_add_u32 m0, s72, 61440
    s_add_u32 s34, s88, 172032
    buffer_load_dwordx4 v10, s[12:15], s34 offen lds
    s_waitcnt vmcnt(12)
    s_barrier
    s_add_u32 m0, s72, 65536
    s_add_u32 s34, s40, 0
    buffer_load_dwordx4 v9, s[4:7], s34 offen lds
    s_add_u32 m0, s72, 69632
    s_add_u32 s34, s40, 32768
    buffer_load_dwordx4 v9, s[4:7], s34 offen lds
    s_add_u32 m0, s72, 73728
    s_add_u32 s34, s40, 65536
    buffer_load_dwordx4 v9, s[4:7], s34 offen lds
    s_add_u32 m0, s72, 77824
    s_add_u32 s34, s40, 98304
    buffer_load_dwordx4 v9, s[4:7], s34 offen lds
    s_add_u32 m0, s72, 0
    s_add_u32 s34, s89, 0
    buffer_load_dwordx4 v10, s[8:11], s34 offen lds
    s_add_u32 m0, s72, 8192
    s_add_u32 s34, s89, 0
    buffer_load_dwordx4 v10, s[12:15], s34 offen lds
    s_add_u32 m0, s72, 4096
    s_add_u32 s34, s89, 57344
    buffer_load_dwordx4 v10, s[8:11], s34 offen lds
    s_add_u32 m0, s72, 12288
    s_add_u32 s34, s89, 57344
    buffer_load_dwordx4 v10, s[12:15], s34 offen lds
    s_waitcnt vmcnt(12)
    s_barrier
    s_add_u32 m0, s72, 81920
    s_add_u32 s34, s41, 0
    buffer_load_dwordx4 v9, s[4:7], s34 offen lds
    s_add_u32 m0, s72, 86016
    s_add_u32 s34, s41, 32768
    buffer_load_dwordx4 v9, s[4:7], s34 offen lds
    s_add_u32 m0, s72, 16384
    s_add_u32 s34, s89, 114688
    buffer_load_dwordx4 v10, s[8:11], s34 offen lds
    s_add_u32 m0, s72, 24576
    s_add_u32 s34, s89, 114688
    buffer_load_dwordx4 v10, s[12:15], s34 offen lds
    s_add_u32 m0, s72, 20480
    s_add_u32 s34, s89, 172032
    buffer_load_dwordx4 v10, s[8:11], s34 offen lds
    s_add_u32 m0, s72, 28672
    s_add_u32 s34, s89, 172032
    buffer_load_dwordx4 v10, s[12:15], s34 offen lds
    s_waitcnt vmcnt(14)
    s_barrier
    s_add_u32 m0, s72, 90112
    s_add_u32 s34, s41, 65536
    buffer_load_dwordx4 v9, s[4:7], s34 offen lds
    s_add_u32 m0, s72, 94208
    s_add_u32 s34, s41, 98304
    buffer_load_dwordx4 v9, s[4:7], s34 offen lds
    s_add_u32 m0, s72, 32768
    s_add_u32 s34, s90, 0
    buffer_load_dwordx4 v10, s[8:11], s34 offen lds
    s_add_u32 m0, s72, 40960
    s_add_u32 s34, s90, 0
    buffer_load_dwordx4 v10, s[12:15], s34 offen lds
    s_add_u32 m0, s72, 36864
    s_add_u32 s34, s90, 57344
    buffer_load_dwordx4 v10, s[8:11], s34 offen lds
    s_add_u32 m0, s72, 45056
    s_add_u32 s34, s90, 57344
    buffer_load_dwordx4 v10, s[12:15], s34 offen lds
    s_waitcnt vmcnt(12)
    s_barrier
    s_add_u32 m0, s72, 98304
    s_add_u32 s34, s42, 0
    buffer_load_dwordx4 v9, s[4:7], s34 offen lds
    s_add_u32 m0, s72, 102400
    s_add_u32 s34, s42, 32768
    buffer_load_dwordx4 v9, s[4:7], s34 offen lds
    s_add_u32 m0, s72, 49152
    s_add_u32 s34, s90, 114688
    buffer_load_dwordx4 v10, s[8:11], s34 offen lds
    s_add_u32 m0, s72, 57344
    s_add_u32 s34, s90, 114688
    buffer_load_dwordx4 v10, s[12:15], s34 offen lds
    s_add_u32 m0, s72, 53248
    s_add_u32 s34, s90, 172032
    buffer_load_dwordx4 v10, s[8:11], s34 offen lds
    s_add_u32 m0, s72, 61440
    s_add_u32 s34, s90, 172032
    buffer_load_dwordx4 v10, s[12:15], s34 offen lds
    s_waitcnt vmcnt(12)
    s_barrier
    s_add_u32 m0, s72, 106496
    s_add_u32 s34, s42, 65536
    buffer_load_dwordx4 v9, s[4:7], s34 offen lds
    s_add_u32 m0, s72, 110592
    s_add_u32 s34, s42, 98304
    buffer_load_dwordx4 v9, s[4:7], s34 offen lds
    s_add_u32 m0, s72, 0
    s_add_u32 s34, s91, 0
    buffer_load_dwordx4 v10, s[8:11], s34 offen lds
    s_add_u32 m0, s72, 8192
    s_add_u32 s34, s91, 0
    buffer_load_dwordx4 v10, s[12:15], s34 offen lds
    s_add_u32 m0, s72, 4096
    s_add_u32 s34, s91, 57344
    buffer_load_dwordx4 v10, s[8:11], s34 offen lds
    s_add_u32 m0, s72, 12288
    s_add_u32 s34, s91, 57344
    buffer_load_dwordx4 v10, s[12:15], s34 offen lds
    s_waitcnt vmcnt(12)
    s_barrier
    s_add_u32 m0, s72, 65536
    s_add_u32 s34, s43, 0
    buffer_load_dwordx4 v9, s[4:7], s34 offen lds
    s_add_u32 m0, s72, 69632
    s_add_u32 s34, s43, 32768
    buffer_load_dwordx4 v9, s[4:7], s34 offen lds
    s_add_u32 m0, s72, 16384
    s_add_u32 s34, s91, 114688
    buffer_load_dwordx4 v10, s[8:11], s34 offen lds
    s_add_u32 m0, s72, 24576
    s_add_u32 s34, s91, 114688
    buffer_load_dwordx4 v10, s[12:15], s34 offen lds
    s_add_u32 m0, s72, 20480
    s_add_u32 s34, s91, 172032
    buffer_load_dwordx4 v10, s[8:11], s34 offen lds
    s_add_u32 m0, s72, 28672
    s_add_u32 s34, s91, 172032
    buffer_load_dwordx4 v10, s[12:15], s34 offen lds
    s_waitcnt vmcnt(12)
    s_barrier
    s_add_u32 m0, s72, 73728
    s_add_u32 s34, s43, 65536
    buffer_load_dwordx4 v9, s[4:7], s34 offen lds
    s_add_u32 m0, s72, 77824
    s_add_u32 s34, s43, 98304
    buffer_load_dwordx4 v9, s[4:7], s34 offen lds
    s_add_u32 m0, s72, 32768
    s_add_u32 s34, s92, 0
    buffer_load_dwordx4 v10, s[8:11], s34 offen lds
    s_add_u32 m0, s72, 40960
    s_add_u32 s34, s92, 0
    buffer_load_dwordx4 v10, s[12:15], s34 offen lds
    s_add_u32 m0, s72, 36864
    s_add_u32 s34, s92, 57344
    buffer_load_dwordx4 v10, s[8:11], s34 offen lds
    s_add_u32 m0, s72, 45056
    s_add_u32 s34, s92, 57344
    buffer_load_dwordx4 v10, s[12:15], s34 offen lds
    s_waitcnt vmcnt(12)
    s_barrier
    s_add_u32 m0, s72, 81920
    s_add_u32 s34, s44, 0
    buffer_load_dwordx4 v9, s[4:7], s34 offen lds
    s_add_u32 m0, s72, 86016
    s_add_u32 s34, s44, 32768
    buffer_load_dwordx4 v9, s[4:7], s34 offen lds
    s_add_u32 m0, s72, 49152
    s_add_u32 s34, s92, 114688
    buffer_load_dwordx4 v10, s[8:11], s34 offen lds
    s_add_u32 m0, s72, 57344
    s_add_u32 s34, s92, 114688
    buffer_load_dwordx4 v10, s[12:15], s34 offen lds
    s_add_u32 m0, s72, 53248
    s_add_u32 s34, s92, 172032
    buffer_load_dwordx4 v10, s[8:11], s34 offen lds
    s_add_u32 m0, s72, 61440
    s_add_u32 s34, s92, 172032
    buffer_load_dwordx4 v10, s[12:15], s34 offen lds
    s_add_u32 m0, s73, 114688
    s_add_u32 s34, s80, 0
    buffer_load_dwordx4 v11, s[20:23], s34 offen lds
    s_waitcnt vmcnt(13)
    s_barrier
    s_add_u32 m0, s72, 90112
    s_add_u32 s34, s44, 65536
    buffer_load_dwordx4 v9, s[4:7], s34 offen lds
    s_add_u32 m0, s72, 94208
    s_add_u32 s34, s44, 98304
    buffer_load_dwordx4 v9, s[4:7], s34 offen lds
    s_add_u32 m0, s72, 0
    s_add_u32 s34, s93, 0
    buffer_load_dwordx4 v10, s[8:11], s34 offen lds
    s_add_u32 m0, s72, 8192
    s_add_u32 s34, s93, 0
    buffer_load_dwordx4 v10, s[12:15], s34 offen lds
    s_add_u32 m0, s72, 4096
    s_add_u32 s34, s93, 57344
    buffer_load_dwordx4 v10, s[8:11], s34 offen lds
    s_add_u32 m0, s72, 12288
    s_add_u32 s34, s93, 57344
    buffer_load_dwordx4 v10, s[12:15], s34 offen lds
    s_add_u32 m0, s73, 115712
    s_add_u32 s34, s80, 8192
    buffer_load_dwordx4 v11, s[20:23], s34 offen lds
    s_waitcnt vmcnt(14)
    s_barrier
    s_add_u32 m0, s72, 98304
    s_add_u32 s34, s45, 0
    buffer_load_dwordx4 v9, s[4:7], s34 offen lds
    s_add_u32 m0, s72, 102400
    s_add_u32 s34, s45, 32768
    buffer_load_dwordx4 v9, s[4:7], s34 offen lds
    s_add_u32 m0, s72, 16384
    s_add_u32 s34, s93, 114688
    buffer_load_dwordx4 v10, s[8:11], s34 offen lds
    s_add_u32 m0, s72, 24576
    s_add_u32 s34, s93, 114688
    buffer_load_dwordx4 v10, s[12:15], s34 offen lds
    s_add_u32 m0, s72, 20480
    s_add_u32 s34, s93, 172032
    buffer_load_dwordx4 v10, s[8:11], s34 offen lds
    s_add_u32 m0, s72, 28672
    s_add_u32 s34, s93, 172032
    buffer_load_dwordx4 v10, s[12:15], s34 offen lds
    s_add_u32 m0, s73, 122880
    s_add_u32 s34, s80, 16384
    buffer_load_dwordx4 v11, s[20:23], s34 offen lds
    s_waitcnt vmcnt(15)
    s_barrier
    s_add_u32 m0, s72, 106496
    s_add_u32 s34, s45, 65536
    buffer_load_dwordx4 v9, s[4:7], s34 offen lds
    s_add_u32 m0, s72, 110592
    s_add_u32 s34, s45, 98304
    buffer_load_dwordx4 v9, s[4:7], s34 offen lds
    s_add_u32 m0, s72, 32768
    s_add_u32 s34, s94, 0
    buffer_load_dwordx4 v10, s[8:11], s34 offen lds
    s_add_u32 m0, s72, 40960
    s_add_u32 s34, s94, 0
    buffer_load_dwordx4 v10, s[12:15], s34 offen lds
    s_add_u32 m0, s72, 36864
    s_add_u32 s34, s94, 57344
    buffer_load_dwordx4 v10, s[8:11], s34 offen lds
    s_add_u32 m0, s72, 45056
    s_add_u32 s34, s94, 57344
    buffer_load_dwordx4 v10, s[12:15], s34 offen lds
    s_add_u32 m0, s73, 123904
    s_add_u32 s34, s80, 24576
    buffer_load_dwordx4 v11, s[20:23], s34 offen lds
    s_waitcnt vmcnt(15)
    s_barrier
    s_add_u32 m0, s72, 49152
    s_add_u32 s34, s94, 114688
    buffer_load_dwordx4 v10, s[8:11], s34 offen lds
    s_add_u32 m0, s72, 57344
    s_add_u32 s34, s94, 114688
    buffer_load_dwordx4 v10, s[12:15], s34 offen lds
    s_add_u32 m0, s72, 53248
    s_add_u32 s34, s94, 172032
    buffer_load_dwordx4 v10, s[8:11], s34 offen lds
    s_add_u32 m0, s72, 61440
    s_add_u32 s34, s94, 172032
    buffer_load_dwordx4 v10, s[12:15], s34 offen lds
    s_add_u32 m0, s73, 65536
    s_add_u32 s34, s80, 32768
    buffer_load_dwordx4 v11, s[20:23], s34 offen lds
    s_add_u32 m0, s73, 66560
    s_add_u32 s34, s80, 40960
    buffer_load_dwordx4 v11, s[20:23], s34 offen lds
    global_load_dword v12, v13, s[66:67] sc1
    s_mov_b32 exec_hi, 0
    buffer_load_dword v14, v15, s[16:19], s74 offen sc1
    s_mov_b64 exec, -1
    s_waitcnt vmcnt(16)
    s_barrier
    s_add_u32 m0, s73, 73728
    s_add_u32 s34, s80, 49152
    buffer_load_dwordx4 v11, s[20:23], s34 offen lds
    s_add_u32 m0, s73, 74752
    s_add_u32 s34, s80, 57344
    buffer_load_dwordx4 v11, s[20:23], s34 offen lds
    s_add_u32 m0, s73, 0
    s_add_u32 s34, s81, 0
    buffer_load_dwordx4 v11, s[20:23], s34 offen lds
    s_add_u32 m0, s73, 1024
    s_add_u32 s34, s81, 8192
    buffer_load_dwordx4 v11, s[20:23], s34 offen lds
    s_add_u32 m0, s73, 8192
    s_add_u32 s34, s81, 16384
    buffer_load_dwordx4 v11, s[20:23], s34 offen lds
    s_add_u32 m0, s73, 9216
    s_add_u32 s34, s81, 24576
    buffer_load_dwordx4 v11, s[20:23], s34 offen lds
    s_waitcnt vmcnt(10)
    s_barrier
    s_add_u32 m0, s73, 16384
    s_add_u32 s34, s81, 32768
    buffer_load_dwordx4 v11, s[20:23], s34 offen lds
    s_add_u32 m0, s73, 17408
    s_add_u32 s34, s81, 40960
    buffer_load_dwordx4 v11, s[20:23], s34 offen lds
    s_add_u32 m0, s73, 24576
    s_add_u32 s34, s81, 49152
    buffer_load_dwordx4 v11, s[20:23], s34 offen lds
    s_add_u32 m0, s73, 25600
    s_add_u32 s34, s81, 57344
    buffer_load_dwordx4 v11, s[20:23], s34 offen lds
    s_add_u32 m0, s73, 81920
    s_add_u32 s34, s82, 0
    buffer_load_dwordx4 v11, s[20:23], s34 offen lds
    s_add_u32 m0, s73, 82944
    s_add_u32 s34, s82, 8192
    buffer_load_dwordx4 v11, s[20:23], s34 offen lds
    s_add_u32 m0, s73, 90112
    s_add_u32 s34, s82, 16384
    buffer_load_dwordx4 v11, s[20:23], s34 offen lds
    s_add_u32 m0, s73, 91136
    s_add_u32 s34, s82, 24576
    buffer_load_dwordx4 v11, s[20:23], s34 offen lds
    s_waitcnt vmcnt(14)
    s_mov_b32 s75, 0
Ltok1:
    v_readfirstlane_b32 s68, v12
    s_add_u32 s75, s75, 1
    s_cmp_lg_u32 s68, 0
    s_cbranch_scc1 Ltok1_ok
    global_load_dword v12, v13, s[66:67] sc1
    s_waitcnt vmcnt(0)
    s_cmp_lt_u32 s75, 131072
    s_cbranch_scc1 Ltok1
Ltok1_ok:
    s_mov_b32 exec_hi, 0
    v_cmp_ne_u32 vcc, s68, v14
    s_mov_b64 exec, -1
    s_mov_b32 s96, vcc_lo
    s_cmp_eq_u32 s96, 0
    s_cselect_b32 s35, s79, 25165824
    s_add_u32 m0, s78, 148864
    s_add_u32 s34, s35, 8388608
    buffer_load_dwordx4 v16, s[16:19], s34 offen sc1 lds
    s_add_u32 m0, s78, 150016
    s_add_u32 s34, s35, 8388640
    buffer_load_dwordx4 v16, s[16:19], s34 offen sc1 lds
    s_barrier
    s_add_u32 m0, s73, 32768
    s_add_u32 s34, s82, 32768
    buffer_load_dwordx4 v11, s[20:23], s34 offen lds
    s_add_u32 m0, s73, 33792
    s_add_u32 s34, s82, 40960
    buffer_load_dwordx4 v11, s[20:23], s34 offen lds
    s_add_u32 m0, s73, 40960
    s_add_u32 s34, s82, 49152
    buffer_load_dwordx4 v11, s[20:23], s34 offen lds
    s_add_u32 m0, s73, 41984
    s_add_u32 s34, s82, 57344
    buffer_load_dwordx4 v11, s[20:23], s34 offen lds
    s_waitcnt vmcnt(4)
    s_cmp_eq_u32 s96, 0
    s_cbranch_scc1 L_uok
    s_waitcnt vmcnt(0)
    s_mov_b64 exec, 1
    ds_add_u32 v7, v8 offset:0
    s_mov_b64 exec, -1
L_tail:
    s_mov_b32 s75, 0
    s_mov_b32 exec_hi, 0
Lpoll2:
    v_cmp_ne_u32 vcc, s68, v14
    s_add_u32 s75, s75, 1
    s_cbranch_vccz Lpoll2_ok
    s_sleep 2
    buffer_load_dword v14, v15, s[16:19], s74 offen sc1
    s_waitcnt vmcnt(0)
    s_cmp_lt_u32 s75, 131072
    s_cbranch_scc1 Lpoll2
Lpoll2_ok:
    s_mov_b64 exec, -1
    s_add_u32 m0, s78, 148864
    s_add_u32 s34, s79, 8388608
    buffer_load_dwordx4 v16, s[16:19], s34 offen sc1 lds
    s_add_u32 m0, s78, 150016
    s_add_u32 s34, s79, 8388640
    buffer_load_dwordx4 v16, s[16:19], s34 offen sc1 lds
    s_waitcnt vmcnt(0)
    s_mov_b32 s96, 1
L_uok:
    ds_read_b64_tr_b16 v[120:121], v19 offset:32
    ds_read_b64_tr_b16 v[122:123], v19 offset:0
    ds_read_b64_tr_b16 v[124:125], v19 offset:288
    ds_read_b64_tr_b16 v[126:127], v19 offset:256
    ds_read_b64_tr_b16 v[128:129], v19 offset:544
    ds_read_b64_tr_b16 v[130:131], v19 offset:512
    ds_read_b64_tr_b16 v[132:133], v19 offset:800
    ds_read_b64_tr_b16 v[134:135], v19 offset:768
    s_waitcnt lgkmcnt(6)
    ds_read_b64_tr_b16 v[136:137], v19 offset:1056
    ds_read_b64_tr_b16 v[138:139], v19 offset:1024
    ds_read_b64_tr_b16 v[140:141], v19 offset:1312
    ds_read_b64_tr_b16 v[142:143], v19 offset:1280
    ds_read_b64_tr_b16 v[144:145], v19 offset:1568
    ds_read_b64_tr_b16 v[146:147], v19 offset:1536
    ds_read_b64_tr_b16 v[148:149], v19 offset:1824
    ds_read_b64_tr_b16 v[150:151], v19 offset:1792
    s_waitcnt lgkmcnt(6)
    ds_read_b64 v[56:57], v20 offset:0
    ds_read_b64 v[58:59], v20 offset:8
    ds_read_b64 v[60:61], v20 offset:64
    ds_read_b64 v[62:63], v20 offset:72
    ds_read_b64 v[64:65], v20 offset:128
    ds_read_b64 v[66:67], v20 offset:136
    ds_read_b64 v[68:69], v20 offset:192
    ds_read_b64 v[70:71], v20 offset:200
    s_waitcnt lgkmcnt(6)
    ds_read_b64 v[72:73], v20 offset:256
    ds_read_b64 v[74:75], v20 offset:264
    ds_read_b64 v[76:77], v20 offset:320
    ds_read_b64 v[78:79], v20 offset:328
    ds_read_b64 v[80:81], v20 offset:384
    ds_read_b64 v[82:83], v20 offset:392
    ds_read_b64 v[84:85], v20 offset:448
    ds_read_b64 v[86:87], v20 offset:456
    s_waitcnt lgkmcnt(6)
    ds_read_b64 v[88:89], v20 offset:512
    ds_read_b64 v[90:91], v20 offset:520
    ds_read_b64 v[92:93], v20 offset:576
    ds_read_b64 v[94:95], v20 offset:584
    ds_read_b64 v[96:97], v20 offset:640
    ds_read_b64 v[98:99], v20 offset:648
    ds_read_b64 v[100:101], v20 offset:704
    ds_read_b64 v[102:103], v20 offset:712
    s_waitcnt lgkmcnt(6)
    ds_read_b64 v[104:105], v20 offset:768
    ds_read_b64 v[106:107], v20 offset:776
    ds_read_b64 v[108:109], v20 offset:832
    ds_read_b64 v[110:111], v20 offset:840
    ds_read_b64 v[112:113], v20 offset:896
    ds_read_b64 v[114:115], v20 offset:904
    ds_read_b64 v[116:117], v20 offset:960
    ds_read_b64 v[118:119], v20 offset:968
    s_waitcnt lgkmcnt(6)
    s_cmp_eq_u32 s96, 0
    s_cselect_b32 s34, 1, 0
    v_mov_b32 v3, s34
    s_waitcnt vmcnt(0)
    s_mov_b64 exec, 1
    ds_add_u32 v7, v3 offset:0
    s_mov_b64 exec, -1
    s_mov_b32 s75, 0
Llw3:
    ds_read_b32 v2, v7 offset:12
    s_add_u32 s75, s75, 1
    s_waitcnt lgkmcnt(0)
    v_readfirstlane_b32 s34, v2
    s_nop 0
    s_cmp_ge_u32 s34, 4
    s_cbranch_scc1 Llw3_ok
    s_sleep 0
    s_cmp_lt_u32 s75, 2097152
    s_cbranch_scc1 Llw3
Llw3_ok:
    s_setprio 0
    v_mfma_f32_16x16x32_bf16 v[24:27], v[120:123], v[60:63], 0
    v_mfma_f32_16x16x32_bf16 v[28:31], v[120:123], v[68:71], 0
    v_mfma_f32_16x16x32_bf16 v[32:35], v[120:123], v[76:79], 0
    v_mfma_f32_16x16x32_bf16 v[36:39], v[120:123], v[84:87], 0
    v_mfma_f32_16x16x32_bf16 v[40:43], v[120:123], v[92:95], 0
    v_mfma_f32_16x16x32_bf16 v[44:47], v[120:123], v[100:103], 0
    v_mfma_f32_16x16x32_bf16 v[48:51], v[120:123], v[108:111], 0
    v_mfma_f32_16x16x32_bf16 v[52:55], v[120:123], v[116:119], 0
    ds_read_b64_tr_b16 v[120:121], v19 offset:2080
    ds_read_b64_tr_b16 v[122:123], v19 offset:2048
    ds_read_b64 v[116:117], v20 offset:2112
    ds_read_b64 v[118:119], v20 offset:2120
    v_mfma_f32_16x16x32_bf16 v[24:27], v[124:127], v[56:59], v[24:27]
    v_mfma_f32_16x16x32_bf16 v[28:31], v[124:127], v[64:67], v[28:31]
    v_mfma_f32_16x16x32_bf16 v[32:35], v[124:127], v[72:75], v[32:35]
    v_mfma_f32_16x16x32_bf16 v[36:39], v[124:127], v[80:83], v[36:39]
    v_mfma_f32_16x16x32_bf16 v[40:43], v[124:127], v[88:91], v[40:43]
    v_mfma_f32_16x16x32_bf16 v[44:47], v[124:127], v[96:99], v[44:47]
    v_mfma_f32_16x16x32_bf16 v[48:51], v[124:127], v[104:107], v[48:51]
    v_mfma_f32_16x16x32_bf16 v[52:55], v[124:127], v[112:115], v[52:55]
    ds_read_b64_tr_b16 v[124:125], v19 offset:2336
    ds_read_b64_tr_b16 v[126:127], v19 offset:2304
    ds_read_b64 v[112:113], v20 offset:2048
    ds_read_b64 v[114:115], v20 offset:2056
    v_mfma_f32_16x16x32_bf16 v[28:31], v[128:131], v[60:63], v[28:31]
    v_mfma_f32_16x16x32_bf16 v[32:35], v[128:131], v[68:71], v[32:35]
    v_mfma_f32_16x16x32_bf16 v[36:39], v[128:131], v[76:79], v[36:39]
    v_mfma_f32_16x16x32_bf16 v[40:43], v[128:131], v[84:87], v[40:43]
    v_mfma_f32_16x16x32_bf16 v[44:47], v[128:131], v[92:95], v[44:47]
    v_mfma_f32_16x16x32_bf16 v[48:51], v[128:131], v[100:103], v[48:51]
    v_mfma_f32_16x16x32_bf16 v[52:55], v[128:131], v[108:111], v[52:55]
    ds_read_b64_tr_b16 v[128:129], v19 offset:2592
    ds_read_b64_tr_b16 v[130:131], v19 offset:2560
    ds_read_b64 v[108:109], v20 offset:1984
    ds_read_b64 v[110:111], v20 offset:1992
    v_mfma_f32_16x16x32_bf16 v[28:31], v[132:135], v[56:59], v[28:31]
    v_mfma_f32_16x16x32_bf16 v[32:35], v[132:135], v[64:67], v[32:35]
    v_mfma_f32_16x16x32_bf16 v[36:39], v[132:135], v[72:75], v[36:39]
    v_mfma_f32_16x16x32_bf16 v[40:43], v[132:135], v[80:83], v[40:43]
    v_mfma_f32_16x16x32_bf16 v[44:47], v[132:135], v[88:91], v[44:47]
    v_mfma_f32_16x16x32_bf16 v[48:51], v[132:135], v[96:99], v[48:51]
    v_mfma_f32_16x16x32_bf16 v[52:55], v[132:135], v[104:107], v[52:55]
    ds_read_b64_tr_b16 v[132:133], v19 offset:2848
    ds_read_b64_tr_b16 v[134:135], v19 offset:2816
    s_waitcnt lgkmcnt(6)
    ds_read_b64 v[104:105], v20 offset:1920
    ds_read_b64 v[106:107], v20 offset:1928
    v_mfma_f32_16x16x32_bf16 v[32:35], v[136:139], v[60:63], v[32:35]
    v_mfma_f32_16x16x32_bf16 v[36:39], v[136:139], v[68:71], v[36:39]
    v_mfma_f32_16x16x32_bf16 v[40:43], v[136:139], v[76:79], v[40:43]
    v_mfma_f32_16x16x32_bf16 v[44:47], v[136:139], v[84:87], v[44:47]
    v_mfma_f32_16x16x32_bf16 v[48:51], v[136:139], v[92:95], v[48:51]
    v_mfma_f32_16x16x32_bf16 v[52:55], v[136:139], v[100:103], v[52:55]
    ds_read_b64_tr_b16 v[136:137], v19 offset:3104
    ds_read_b64_tr_b16 v[138:139], v19 offset:3072
    ds_read_b64 v[100:101], v20 offset:1856
    ds_read_b64 v[102:103], v20 offset:1864
    v_mfma_f32_16x16x32_bf16 v[32:35], v[140:143], v[56:59], v[32:35]
    v_mfma_f32_16x16x32_bf16 v[36:39], v[140:143], v[64:67], v[36:39]
    v_mfma_f32_16x16x32_bf16 v[40:43], v[140:143], v[72:75], v[40:43]
    v_mfma_f32_16x16x32_bf16 v[44:47], v[140:143], v[80:83], v[44:47]
    v_mfma_f32_16x16x32_bf16 v[48:51], v[140:143], v[88:91], v[48:51]
    v_mfma_f32_16x16x32_bf16 v[52:55], v[140:143], v[96:99], v[52:55]
    ds_read_b64_tr_b16 v[140:141], v19 offset:3360
    ds_read_b64_tr_b16 v[142:143], v19 offset:3328
    s_waitcnt lgkmcnt(6)
    ds_read_b64 v[96:97], v20 offset:1792
    ds_read_b64 v[98:99], v20 offset:1800
    v_mfma_f32_16x16x32_bf16 v[36:39], v[144:147], v[60:63], v[36:39]
    v_mfma_f32_16x16x32_bf16 v[40:43], v[144:147], v[68:71], v[40:43]
    v_mfma_f32_16x16x32_bf16 v[44:47], v[144:147], v[76:79], v[44:47]
    v_mfma_f32_16x16x32_bf16 v[48:51], v[144:147], v[84:87], v[48:51]
    v_mfma_f32_16x16x32_bf16 v[52:55], v[144:147], v[92:95], v[52:55]
    ds_read_b64_tr_b16 v[144:145], v19 offset:3616
    ds_read_b64_tr_b16 v[146:147], v19 offset:3584
    ds_read_b64 v[92:93], v20 offset:1728
    ds_read_b64 v[94:95], v20 offset:1736
    v_mfma_f32_16x16x32_bf16 v[36:39], v[148:151], v[56:59], v[36:39]
    v_mfma_f32_16x16x32_bf16 v[40:43], v[148:151], v[64:67], v[40:43]
    v_mfma_f32_16x16x32_bf16 v[44:47], v[148:151], v[72:75], v[44:47]
    v_mfma_f32_16x16x32_bf16 v[48:51], v[148:151], v[80:83], v[48:51]
    v_mfma_f32_16x16x32_bf16 v[52:55], v[148:151], v[88:91], v[52:55]
    ds_read_b64_tr_b16 v[148:149], v19 offset:3872
    ds_read_b64_tr_b16 v[150:151], v19 offset:3840
    s_waitcnt lgkmcnt(6)
    ds_read_b64 v[88:89], v20 offset:1664
    ds_read_b64 v[90:91], v20 offset:1672
    v_mfma_f32_16x16x32_bf16 v[40:43], v[120:123], v[60:63], v[40:43]
    v_mfma_f32_16x16x32_bf16 v[44:47], v[120:123], v[68:71], v[44:47]
    v_mfma_f32_16x16x32_bf16 v[48:51], v[120:123], v[76:79], v[48:51]
    v_mfma_f32_16x16x32_bf16 v[52:55], v[120:123], v[84:87], v[52:55]
    ds_read_b64_tr_b16 v[120:121], v19 offset:4192
    ds_read_b64_tr_b16 v[122:123], v19 offset:4160
    ds_read_b64 v[84:85], v20 offset:1600
    ds_read_b64 v[86:87], v20 offset:1608
    v_mfma_f32_16x16x32_bf16 v[40:43], v[124:127], v[56:59], v[40:43]
    v_mfma_f32_16x16x32_bf16 v[44:47], v[124:127], v[64:67], v[44:47]
    v_mfma_f32_16x16x32_bf16 v[48:51], v[124:127], v[72:75], v[48:51]
    v_mfma_f32_16x16x32_bf16 v[52:55], v[124:127], v[80:83], v[52:55]
    ds_read_b64_tr_b16 v[124:125], v19 offset:4448
    ds_read_b64_tr_b16 v[126:127], v19 offset:4416
    s_waitcnt lgkmcnt(6)
    ds_read_b64 v[80:81], v20 offset:1536
    ds_read_b64 v[82:83], v20 offset:1544
    v_mfma_f32_16x16x32_bf16 v[44:47], v[128:131], v[60:63], v[44:47]
    v_mfma_f32_16x16x32_bf16 v[48:51], v[128:131], v[68:71], v[48:51]
    v_mfma_f32_16x16x32_bf16 v[52:55], v[128:131], v[76:79], v[52:55]
    ds_read_b64_tr_b16 v[128:129], v19 offset:4704
    ds_read_b64_tr_b16 v[130:131], v19 offset:4672
    ds_read_b64 v[76:77], v20 offset:1472
    ds_read_b64 v[78:79], v20 offset:1480
    v_mfma_f32_16x16x32_bf16 v[44:47], v[132:135], v[56:59], v[44:47]
    v_mfma_f32_16x16x32_bf16 v[48:51], v[132:135], v[64:67], v[48:51]
    v_mfma_f32_16x16x32_bf16 v[52:55], v[132:135], v[72:75], v[52:55]
    ds_read_b64_tr_b16 v[132:133], v19 offset:4960
    ds_read_b64_tr_b16 v[134:135], v19 offset:4928
    s_waitcnt lgkmcnt(6)
    ds_read_b64 v[72:73], v20 offset:1408
    ds_read_b64 v[74:75], v20 offset:1416
    v_mfma_f32_16x16x32_bf16 v[48:51], v[136:139], v[60:63], v[48:51]
    v_mfma_f32_16x16x32_bf16 v[52:55], v[136:139], v[68:71], v[52:55]
    ds_read_b64_tr_b16 v[136:137], v19 offset:5216
    ds_read_b64_tr_b16 v[138:139], v19 offset:5184
    ds_read_b64 v[68:69], v20 offset:1344
    ds_read_b64 v[70:71], v20 offset:1352
    v_mfma_f32_16x16x32_bf16 v[48:51], v[140:143], v[56:59], v[48:51]
    v_mfma_f32_16x16x32_bf16 v[52:55], v[140:143], v[64:67], v[52:55]
    ds_read_b64_tr_b16 v[140:141], v19 offset:5472
    ds_read_b64_tr_b16 v[142:143], v19 offset:5440
    s_waitcnt lgkmcnt(6)
    ds_read_b64 v[64:65], v20 offset:1280
    ds_read_b64 v[66:67], v20 offset:1288
    v_mfma_f32_16x16x32_bf16 v[52:55], v[144:147], v[60:63], v[52:55]
    ds_read_b64_tr_b16 v[144:145], v19 offset:5728
    ds_read_b64_tr_b16 v[146:147], v19 offset:5696
    ds_read_b64 v[60:61], v20 offset:1216
    ds_read_b64 v[62:63], v20 offset:1224
    v_mfma_f32_16x16x32_bf16 v[52:55], v[148:151], v[56:59], v[52:55]
    ds_read_b64_tr_b16 v[148:149], v19 offset:5984
    ds_read_b64_tr_b16 v[150:151], v19 offset:5952
    s_waitcnt lgkmcnt(6)
    ds_read_b64 v[56:57], v20 offset:1152
    ds_read_b64 v[58:59], v20 offset:1160
    s_waitcnt lgkmcnt(4)
    v_mfma_f32_16x16x32_bf16 v[24:27], v[120:123], v[60:63], v[24:27]
    v_mfma_f32_16x16x32_bf16 v[28:31], v[120:123], v[68:71], v[28:31]
    v_mfma_f32_16x16x32_bf16 v[32:35], v[120:123], v[76:79], v[32:35]
    v_mfma_f32_16x16x32_bf16 v[36:39], v[120:123], v[84:87], v[36:39]
    v_mfma_f32_16x16x32_bf16 v[40:43], v[120:123], v[92:95], v[40:43]
    v_mfma_f32_16x16x32_bf16 v[44:47], v[120:123], v[100:103], v[44:47]
    v_mfma_f32_16x16x32_bf16 v[48:51], v[120:123], v[108:111], v[48:51]
    v_mfma_f32_16x16x32_bf16 v[52:55], v[120:123], v[116:119], v[52:55]
    ds_read_b64_tr_b16 v[120:121], v19 offset:6240
    ds_read_b64_tr_b16 v[122:123], v19 offset:6208
    s_waitcnt lgkmcnt(2)
    v_mfma_f32_16x16x32_bf16 v[24:27], v[124:127], v[56:59], v[24:27]
    v_mfma_f32_16x16x32_bf16 v[28:31], v[124:127], v[64:67], v[28:31]
    v_mfma_f32_16x16x32_bf16 v[32:35], v[124:127], v[72:75], v[32:35]
    v_mfma_f32_16x16x32_bf16 v[36:39], v[124:127], v[80:83], v[36:39]
    v_mfma_f32_16x16x32_bf16 v[40:43], v[124:127], v[88:91], v[40:43]
    v_mfma_f32_16x16x32_bf16 v[44:47], v[124:127], v[96:99], v[44:47]
    v_mfma_f32_16x16x32_bf16 v[48:51], v[124:127], v[104:107], v[48:51]
    v_mfma_f32_16x16x32_bf16 v[52:55], v[124:127], v[112:115], v[52:55]
    ds_read_b64_tr_b16 v[124:125], v19 offset:6496
    ds_read_b64_tr_b16 v[126:127], v19 offset:6464
    v_mfma_f32_16x16x32_bf16 v[28:31], v[128:131], v[60:63], v[28:31]
    v_mfma_f32_16x16x32_bf16 v[32:35], v[128:131], v[68:71], v[32:35]
    v_mfma_f32_16x16x32_bf16 v[36:39], v[128:131], v[76:79], v[36:39]
    v_mfma_f32_16x16x32_bf16 v[40:43], v[128:131], v[84:87], v[40:43]
    v_mfma_f32_16x16x32_bf16 v[44:47], v[128:131], v[92:95], v[44:47]
    v_mfma_f32_16x16x32_bf16 v[48:51], v[128:131], v[100:103], v[48:51]
    v_mfma_f32_16x16x32_bf16 v[52:55], v[128:131], v[108:111], v[52:55]
    ds_read_b64_tr_b16 v[128:129], v19 offset:6752
    ds_read_b64_tr_b16 v[130:131], v19 offset:6720
    v_mfma_f32_16x16x32_bf16 v[28:31], v[132:135], v[56:59], v[28:31]
    v_mfma_f32_16x16x32_bf16 v[32:35], v[132:135], v[64:67], v[32:35]
    v_mfma_f32_16x16x32_bf16 v[36:39], v[132:135], v[72:75], v[36:39]
    v_mfma_f32_16x16x32_bf16 v[40:43], v[132:135], v[80:83], v[40:43]
    v_mfma_f32_16x16x32_bf16 v[44:47], v[132:135], v[88:91], v[44:47]
    v_mfma_f32_16x16x32_bf16 v[48:51], v[132:135], v[96:99], v[48:51]
    v_mfma_f32_16x16x32_bf16 v[52:55], v[132:135], v[104:107], v[52:55]
    ds_read_b64_tr_b16 v[132:133], v19 offset:7008
    ds_read_b64_tr_b16 v[134:135], v19 offset:6976
    v_mfma_f32_16x16x32_bf16 v[32:35], v[136:139], v[60:63], v[32:35]
    v_mfma_f32_16x16x32_bf16 v[36:39], v[136:139], v[68:71], v[36:39]
    v_mfma_f32_16x16x32_bf16 v[40:43], v[136:139], v[76:79], v[40:43]
    v_mfma_f32_16x16x32_bf16 v[44:47], v[136:139], v[84:87], v[44:47]
    v_mfma_f32_16x16x32_bf16 v[48:51], v[136:139], v[92:95], v[48:51]
    v_mfma_f32_16x16x32_bf16 v[52:55], v[136:139], v[100:103], v[52:55]
    ds_read_b64_tr_b16 v[136:137], v19 offset:7264
    ds_read_b64_tr_b16 v[138:139], v19 offset:7232
    v_mfma_f32_16x16x32_bf16 v[32:35], v[140:143], v[56:59], v[32:35]
    v_mfma_f32_16x16x32_bf16 v[36:39], v[140:143], v[64:67], v[36:39]
    v_mfma_f32_16x16x32_bf16 v[40:43], v[140:143], v[72:75], v[40:43]
    v_mfma_f32_16x16x32_bf16 v[44:47], v[140:143], v[80:83], v[44:47]
    v_mfma_f32_16x16x32_bf16 v[48:51], v[140:143], v[88:91], v[48:51]
    v_mfma_f32_16x16x32_bf16 v[52:55], v[140:143], v[96:99], v[52:55]
    ds_read_b64_tr_b16 v[140:141], v19 offset:7520
    ds_read_b64_tr_b16 v[142:143], v19 offset:7488
    v_mfma_f32_16x16x32_bf16 v[36:39], v[144:147], v[60:63], v[36:39]
    v_mfma_f32_16x16x32_bf16 v[40:43], v[144:147], v[68:71], v[40:43]
    v_mfma_f32_16x16x32_bf16 v[44:47], v[144:147], v[76:79], v[44:47]
    v_mfma_f32_16x16x32_bf16 v[48:51], v[144:147], v[84:87], v[48:51]
    v_mfma_f32_16x16x32_bf16 v[52:55], v[144:147], v[92:95], v[52:55]
    ds_read_b64_tr_b16 v[144:145], v19 offset:7776
    ds_read_b64_tr_b16 v[146:147], v19 offset:7744
    v_mfma_f32_16x16x32_bf16 v[36:39], v[148:151], v[56:59], v[36:39]
    v_mfma_f32_16x16x32_bf16 v[40:43], v[148:151], v[64:67], v[40:43]
    v_mfma_f32_16x16x32_bf16 v[44:47], v[148:151], v[72:75], v[44:47]
    v_mfma_f32_16x16x32_bf16 v[48:51], v[148:151], v[80:83], v[48:51]
    v_mfma_f32_16x16x32_bf16 v[52:55], v[148:151], v[88:91], v[52:55]
    s_waitcnt lgkmcnt(6)
    ds_read_b64_tr_b16 v[148:149], v19 offset:8032
    ds_read_b64_tr_b16 v[150:151], v19 offset:8000
    v_mfma_f32_16x16x32_bf16 v[40:43], v[120:123], v[60:63], v[40:43]
    v_mfma_f32_16x16x32_bf16 v[44:47], v[120:123], v[68:71], v[44:47]
    v_mfma_f32_16x16x32_bf16 v[48:51], v[120:123], v[76:79], v[48:51]
    v_mfma_f32_16x16x32_bf16 v[52:55], v[120:123], v[84:87], v[52:55]
    v_mfma_f32_16x16x32_bf16 v[40:43], v[124:127], v[56:59], v[40:43]
    v_mfma_f32_16x16x32_bf16 v[44:47], v[124:127], v[64:67], v[44:47]
    v_mfma_f32_16x16x32_bf16 v[48:51], v[124:127], v[72:75], v[48:51]
    v_mfma_f32_16x16x32_bf16 v[52:55], v[124:127], v[80:83], v[52:55]
    v_mfma_f32_16x16x32_bf16 v[44:47], v[128:131], v[60:63], v[44:47]
    v_mfma_f32_16x16x32_bf16 v[48:51], v[128:131], v[68:71], v[48:51]
    v_mfma_f32_16x16x32_bf16 v[52:55], v[128:131], v[76:79], v[52:55]
    v_mfma_f32_16x16x32_bf16 v[44:47], v[132:135], v[56:59], v[44:47]
    v_mfma_f32_16x16x32_bf16 v[48:51], v[132:135], v[64:67], v[48:51]
    v_mfma_f32_16x16x32_bf16 v[52:55], v[132:135], v[72:75], v[52:55]
    s_waitcnt lgkmcnt(6)
    v_mfma_f32_16x16x32_bf16 v[48:51], v[136:139], v[60:63], v[48:51]
    v_mfma_f32_16x16x32_bf16 v[52:55], v[136:139], v[68:71], v[52:55]
    s_waitcnt lgkmcnt(4)
    v_mfma_f32_16x16x32_bf16 v[48:51], v[140:143], v[56:59], v[48:51]
    v_mfma_f32_16x16x32_bf16 v[52:55], v[140:143], v[64:67], v[52:55]
    s_waitcnt lgkmcnt(2)
    v_mfma_f32_16x16x32_bf16 v[52:55], v[144:147], v[60:63], v[52:55]
    s_waitcnt lgkmcnt(0)
    v_mfma_f32_16x16x32_bf16 v[52:55], v[148:151], v[56:59], v[52:55]
    s_setprio 3
    s_lshl_b32 s34, s69, 13
    s_add_u32 s34, s34, 98304
    v_lshlrev_b32 v5, 4, v1
    v_add_u32 v3, s34, v5
    s_mov_b32 s75, 0
Llw4:
    ds_read_b32 v2, v7 offset:8
    s_add_u32 s75, s75, 1
    s_waitcnt lgkmcnt(0)
    v_readfirstlane_b32 s34, v2
    s_nop 0
    s_cmp_ge_u32 s34, 4
    s_cbranch_scc1 Llw4_ok
    s_sleep 0
    s_cmp_lt_u32 s75, 2097152
    s_cbranch_scc1 Llw4
Llw4_ok:
    ds_write_b128 v3, v[24:27] offset:0
    ds_write_b128 v3, v[28:31] offset:1024
    ds_write_b128 v3, v[32:35] offset:2048
    ds_write_b128 v3, v[36:39] offset:3072
    ds_write_b128 v3, v[40:43] offset:4096
    ds_write_b128 v3, v[44:47] offset:5120
    ds_write_b128 v3, v[48:51] offset:6144
    ds_write_b128 v3, v[52:55] offset:7168
    s_mov_b64 exec, 1
    ds_add_u32 v7, v8 offset:4
    s_mov_b64 exec, -1
    s_add_u32 s35, s73, 98304
    v_add_u32 v3, s35, v5
    v_subrev_u32 v4, 16, v1
    v_cmp_gt_u32 vcc, 16, v1
    v_add_u32 v5, 47, v1
    s_add_u32 s35, s35, 8204
    v_cndmask_b32 v4, v4, v5, vcc
    v_cmp_eq_u32 vcc, 0, v1
    v_lshlrev_b32 v19, 6, v17
    v_lshl_add_u32 v19, v18, 4, v19
    v_cndmask_b32 v4, v4, -1, vcc
    v_lshlrev_b32 v4, 4, v4
    v_add_u32 v4, s35, v4
    v_mov_b32 v121, s68
    v_mov_b32 v123, s68
    v_mov_b32 v125, s68
    v_mov_b32 v127, s68
    v_mov_b32 v129, s68
    v_mov_b32 v131, s68
    v_mov_b32 v133, s68
    v_mov_b32 v135, s68
    s_mov_b32 s75, 0
Llw5:
    ds_read_b32 v2, v7 offset:4
    s_add_u32 s75, s75, 1
    s_waitcnt lgkmcnt(0)
    v_readfirstlane_b32 s34, v2
    s_nop 0
    s_cmp_ge_u32 s34, 4
    s_cbranch_scc1 Llw5_ok
    s_sleep 0
    s_cmp_lt_u32 s75, 2097152
    s_cbranch_scc1 Llw5
Llw5_ok:
    ds_read_b128 v[56:59], v3 offset:0
    ds_read_b128 v[60:63], v3 offset:8192
    ds_read_b32 v64, v4 offset:0
    ds_read_b128 v[68:71], v3 offset:16384
    ds_read_b128 v[72:75], v3 offset:24576
    ds_read_b32 v76, v4 offset:16384
    ds_read_b128 v[80:83], v3 offset:1024
    ds_read_b128 v[84:87], v3 offset:9216
    ds_read_b32 v88, v4 offset:1024
    ds_read_b128 v[92:95], v3 offset:17408
    ds_read_b128 v[96:99], v3 offset:25600
    ds_read_b32 v100, v4 offset:17408
    s_lshl_b32 s34, s2, 14
    s_lshl_b32 s35, s69, 12
    s_add_u32 s34, s34, s35
    s_add_u32 s34, s34, 10485760
    v_cmp_eq_u32 vcc, 256, v0
    s_waitcnt lgkmcnt(0)
    s_nop 0
    v_cndmask_b32 v64, v64, 0, vcc
    v_cndmask_b32 v76, v76, 0, vcc
    v_add_f32 v56, v56, v64
    v_add_f32 v57, v57, v60
    v_add_f32 v58, v58, v61
    v_add_f32 v59, v59, v62
    v_add_f32 v68, v68, v76
    v_add_f32 v69, v69, v72
    v_add_f32 v70, v70, v73
    v_add_f32 v71, v71, v74
    v_cvt_pk_bf16_f32 v120, v56, v68
    v_cvt_pk_bf16_f32 v122, v57, v69
    v_cvt_pk_bf16_f32 v124, v58, v70
    v_cvt_pk_bf16_f32 v126, v59, v71
    buffer_store_dwordx4 v[120:123], v19, s[16:19], s34 offen offset:0 sc1
    buffer_store_dwordx4 v[124:127], v19, s[16:19], s34 offen offset:1024 sc1
    v_add_f32 v80, v80, v88
    v_add_f32 v81, v81, v84
    v_add_f32 v82, v82, v85
    v_add_f32 v83, v83, v86
    v_add_f32 v92, v92, v100
    v_add_f32 v93, v93, v96
    v_add_f32 v94, v94, v97
    v_add_f32 v95, v95, v98
    v_cvt_pk_bf16_f32 v128, v80, v92
    v_cvt_pk_bf16_f32 v130, v81, v93
    v_cvt_pk_bf16_f32 v132, v82, v94
    v_cvt_pk_bf16_f32 v134, v83, v95
    buffer_store_dwordx4 v[128:131], v19, s[16:19], s34 offen offset:2048 sc1
    buffer_store_dwordx4 v[132:135], v19, s[16:19], s34 offen offset:3072 sc1
    s_endpgm
L_aux:
    s_mov_b32 s70, s32
    s_lshl_b32 s34, s70, 16
    s_lshl_b32 s35, s69, 14
    s_add_u32 s34, s34, s35
    s_and_b32 s71, s69, 2
    s_lshl_b32 s71, s71, 4
    v_lshlrev_b32 v185, 4, v1
    v_xor_b32 v182, s71, v185
    v_add_u32 v182, s35, v182
    s_waitcnt lgkmcnt(0)
    s_mov_b32 s4, s36
    s_mov_b32 s5, s37
    s_mov_b32 s6, 2097152
    s_mov_b32 s7, 0x20000
    buffer_load_dwordx4 v[24:27], v185, s[4:7], s34 offen offset:0
    buffer_load_dwordx4 v[28:31], v185, s[4:7], s34 offen offset:1024
    buffer_load_dwordx4 v[32:35], v185, s[4:7], s34 offen offset:2048
    buffer_load_dwordx4 v[36:39], v185, s[4:7], s34 offen offset:3072
    s_add_u32 s34, s34, 4096
    buffer_load_dwordx4 v[40:43], v185, s[4:7], s34 offen offset:0
    buffer_load_dwordx4 v[44:47], v185, s[4:7], s34 offen offset:1024
    buffer_load_dwordx4 v[48:51], v185, s[4:7], s34 offen offset:2048
    buffer_load_dwordx4 v[52:55], v185, s[4:7], s34 offen offset:3072
    s_add_u32 s34, s34, 4096
    buffer_load_dwordx4 v[56:59], v185, s[4:7], s34 offen offset:0
    buffer_load_dwordx4 v[60:63], v185, s[4:7], s34 offen offset:1024
    buffer_load_dwordx4 v[64:67], v185, s[4:7], s34 offen offset:2048
    buffer_load_dwordx4 v[68:71], v185, s[4:7], s34 offen offset:3072
    s_add_u32 s34, s34, 4096
    buffer_load_dwordx4 v[72:75], v185, s[4:7], s34 offen offset:0
    buffer_load_dwordx4 v[76:79], v185, s[4:7], s34 offen offset:1024
    buffer_load_dwordx4 v[80:83], v185, s[4:7], s34 offen offset:2048
    buffer_load_dwordx4 v[84:87], v185, s[4:7], s34 offen offset:3072
    s_add_u32 s34, s34, 4096
    global_load_dwordx4 v[152:155], v185, s[62:63]
    s_mov_b32 s20, s60
    s_mov_b32 s21, s61
    s_mov_b32 s22, 1835008
    s_mov_b32 s23, 0x20000
    v_bfe_u32 v2, v1, 4, 1
    v_lshlrev_b32 v2, 2, v2
    v_xor_b32 v2, v2, v1
    v_and_b32 v2, 7, v2
    v_lshlrev_b32 v2, 4, v2
    v_lshrrev_b32 v11, 3, v1
    v_lshl_add_u32 v11, v11, 10, v2
    s_mul_i32 s34, s69, 458752
    s_lshl_b32 s35, s33, 7
    s_add_u32 s34, s34, s35
    s_and_b32 s35, s32, 3
    s_lshl_b32 s35, s35, 1
    s_add_u32 s35, s35, s33
    s_cmp_ge_u32 s35, 7
    s_cselect_b32 s80, 7, 0
    s_sub_u32 s35, s35, s80
    s_lshl_b32 s35, s35, 12
    s_lshl_b32 s80, s35, 4
    s_add_u32 s80, s80, s34
    s_add_u32 s35, s35, 4096
    s_cmp_eq_u32 s35, 28672
    s_cselect_b32 s35, 0, s35
    s_lshl_b32 s81, s35, 4
    s_add_u32 s81, s81, s34
    s_add_u32 s35, s35, 4096
    s_cmp_eq_u32 s35, 28672
    s_cselect_b32 s35, 0, s35
    s_lshl_b32 s82, s35, 4
    s_add_u32 s82, s82, s34
    s_add_u32 s35, s35, 4096
    s_cmp_eq_u32 s35, 28672
    s_cselect_b32 s35, 0, s35
    s_lshl_b32 s83, s35, 4
    s_add_u32 s83, s83, s34
    s_add_u32 s35, s35, 4096
    s_cmp_eq_u32 s35, 28672
    s_cselect_b32 s35, 0, s35
    s_lshl_b32 s84, s35, 4
    s_add_u32 s84, s84, s34
    s_add_u32 s35, s35, 4096
    s_cmp_eq_u32 s35, 28672
    s_cselect_b32 s35, 0, s35
    s_lshl_b32 s85, s35, 4
    s_add_u32 s85, s85, s34
    s_add_u32 s35, s35, 4096
    s_cmp_eq_u32 s35, 28672
    s_cselect_b32 s35, 0, s35
    s_lshl_b32 s86, s35, 4
    s_add_u32 s86, s86, s34
    s_lshl_b32 s73, s69, 11
    v_lshlrev_b32 v15, 2, v1
    s_lshr_b32 s74, s2, 6
    s_lshl_b32 s74, s74, 7
    s_add_u32 s74, s74, 16252928
    v_lshrrev_b32 v16, 1, v1
    v_lshlrev_b32 v16, 16, v16
    v_and_b32 v2, 1, v1
    v_lshl_add_u32 v16, v2, 4, v16
    v_and_b32 v17, 15, v1
    v_lshrrev_b32 v18, 4, v1
    s_and_b32 s35, s69, 2
    s_mul_i32 s35, s35, 4160
    s_add_u32 s35, s35, 132320
    v_and_b32 v2, 3, v1
    v_bfe_u32 v4, v1, 2, 2
    v_sub_u32 v2, v2, v4
    v_lshlrev_b32 v4, 3, v18
    v_sub_u32 v2, v2, v4
    v_lshlrev_b32 v2, 3, v2
    v_add_u32 v19, s35, v2
    s_mul_i32 s78, s69, 2304
    s_add_u32 s35, s78, 148744
    v_lshlrev_b32 v2, 3, v17
    v_lshl_add_u32 v2, v18, 4, v2
    v_add_u32 v20, s35, v2
    s_lshl_b32 s79, s2, 8
    s_and_b32 s35, s69, 1
    s_lshl_b32 s35, s35, 7
    s_add_u32 s79, s79, s35
    s_and_b32 s35, s69, 2
    s_lshl_b32 s35, s35, 5
    s_add_u32 s79, s79, s35
    v_bfe_u32 v2, v1, 2, 2
    v_bfe_u32 v3, v1, 4, 1
    v_lshrrev_b32 v4, 5, v1
    v_lshlrev_b32 v183, 15, v3
    v_lshl_add_u32 v183, v2, 12, v183
    v_lshl_add_u32 v183, v4, 11, v183
    v_lshl_add_u32 v4, v2, 1, v3
    v_lshl_add_u32 v183, v4, 5, v183
    s_lshl_b32 s34, s69, 8
    v_add_u32 v183, s34, v183
    v_and_b32 v2, 3, v1
    v_lshl_add_u32 v183, v2, 3, v183
    v_bfe_u32 v2, v1, 1, 3
    v_lshlrev_b32 v184, 8, v2
    v_and_b32 v2, 1, v1
    v_lshl_add_u32 v184, v2, 6, v184
    v_lshl_add_u32 v184, v18, 4, v184
    s_waitcnt vmcnt(16)
    v_xor_b32 v2, 0, v182
    ds_write_b128 v2, v[24:27] offset:0
    s_waitcnt vmcnt(15)
    v_xor_b32 v2, 0, v182
    ds_write_b128 v2, v[28:31] offset:1024
    s_waitcnt vmcnt(14)
    v_xor_b32 v2, 0, v182
    ds_write_b128 v2, v[32:35] offset:2048
    s_waitcnt vmcnt(13)
    v_xor_b32 v2, 0, v182
    ds_write_b128 v2, v[36:39] offset:3072
    s_waitcnt vmcnt(12)
    v_xor_b32 v2, 64, v182
    ds_write_b128 v2, v[40:43] offset:4096
    s_waitcnt vmcnt(11)
    v_xor_b32 v2, 64, v182
    ds_write_b128 v2, v[44:47] offset:5120
    s_waitcnt vmcnt(10)
    v_xor_b32 v2, 64, v182
    ds_write_b128 v2, v[48:51] offset:6144
    s_waitcnt vmcnt(9)
    v_xor_b32 v2, 64, v182
    ds_write_b128 v2, v[52:55] offset:7168
    s_waitcnt vmcnt(8)
    v_xor_b32 v2, 128, v182
    ds_write_b128 v2, v[56:59] offset:8192
    s_waitcnt vmcnt(7)
    v_xor_b32 v2, 128, v182
    ds_write_b128 v2, v[60:63] offset:9216
    s_waitcnt vmcnt(6)
    v_xor_b32 v2, 128, v182
    ds_write_b128 v2, v[64:67] offset:10240
    s_waitcnt vmcnt(5)
    v_xor_b32 v2, 128, v182
    ds_write_b128 v2, v[68:71] offset:11264
    s_waitcnt vmcnt(4)
    v_xor_b32 v2, 192, v182
    ds_write_b128 v2, v[72:75] offset:12288
    s_waitcnt vmcnt(3)
    v_xor_b32 v2, 192, v182
    ds_write_b128 v2, v[76:79] offset:13312
    s_waitcnt vmcnt(2)
    v_xor_b32 v2, 192, v182
    ds_write_b128 v2, v[80:83] offset:14336
    s_waitcnt vmcnt(1)
    v_xor_b32 v2, 192, v182
    ds_write_b128 v2, v[84:87] offset:15360
    global_load_dword v12, v13, s[66:67] sc1
    s_waitcnt lgkmcnt(0)
    s_barrier
    s_lshl_b32 s34, s69, 14
    s_lshl_b32 s35, s70, 16
    s_add_u32 s34, s34, s35
    s_add_u32 s34, s34, 8388608
    v_xor_b32 v2, 0, v183
    ds_read_b64_tr_b16 v[88:89], v2 offset:0
    ds_read_b64_tr_b16 v[90:91], v2 offset:16384
    ds_read_b64_tr_b16 v[92:93], v2 offset:1024
    ds_read_b64_tr_b16 v[94:95], v2 offset:17408
    v_xor_b32 v2, 32, v183
    ds_read_b64_tr_b16 v[96:97], v2 offset:0
    ds_read_b64_tr_b16 v[98:99], v2 offset:16384
    ds_read_b64_tr_b16 v[100:101], v2 offset:1024
    ds_read_b64_tr_b16 v[102:103], v2 offset:17408
    s_waitcnt lgkmcnt(4)
    buffer_store_dwordx4 v[88:91], v184, s[16:19], s34 offen offset:0 sc1
    buffer_store_dwordx4 v[92:95], v184, s[16:19], s34 offen offset:128 sc1
    s_add_u32 s34, s34, 2048
    v_xor_b32 v2, 64, v183
    ds_read_b64_tr_b16 v[104:105], v2 offset:0
    ds_read_b64_tr_b16 v[106:107], v2 offset:16384
    ds_read_b64_tr_b16 v[108:109], v2 offset:1024
    ds_read_b64_tr_b16 v[110:111], v2 offset:17408
    s_waitcnt lgkmcnt(4)
    buffer_store_dwordx4 v[96:99], v184, s[16:19], s34 offen offset:0 sc1
    buffer_store_dwordx4 v[100:103], v184, s[16:19], s34 offen offset:128 sc1
    s_add_u32 s34, s34, 2048
    v_xor_b32 v2, 96, v183
    ds_read_b64_tr_b16 v[112:113], v2 offset:0
    ds_read_b64_tr_b16 v[114:115], v2 offset:16384
    ds_read_b64_tr_b16 v[116:117], v2 offset:1024
    ds_read_b64_tr_b16 v[118:119], v2 offset:17408
    s_waitcnt lgkmcnt(4)
    buffer_store_dwordx4 v[104:107], v184, s[16:19], s34 offen offset:0 sc1
    buffer_store_dwordx4 v[108:111], v184, s[16:19], s34 offen offset:128 sc1
    s_add_u32 s34, s34, 2048
    v_xor_b32 v2, 128, v183
    ds_read_b64_tr_b16 v[120:121], v2 offset:0
    ds_read_b64_tr_b16 v[122:123], v2 offset:16384
    ds_read_b64_tr_b16 v[124:125], v2 offset:1024
    ds_read_b64_tr_b16 v[126:127], v2 offset:17408
    s_waitcnt lgkmcnt(4)
    buffer_store_dwordx4 v[112:115], v184, s[16:19], s34 offen offset:0 sc1
    buffer_store_dwordx4 v[116:119], v184, s[16:19], s34 offen offset:128 sc1
    s_add_u32 s34, s34, 2048
    v_xor_b32 v2, 160, v183
    ds_read_b64_tr_b16 v[128:129], v2 offset:0
    ds_read_b64_tr_b16 v[130:131], v2 offset:16384
    ds_read_b64_tr_b16 v[132:133], v2 offset:1024
    ds_read_b64_tr_b16 v[134:135], v2 offset:17408
    s_waitcnt lgkmcnt(4)
    buffer_store_dwordx4 v[120:123], v184, s[16:19], s34 offen offset:0 sc1
    buffer_store_dwordx4 v[124:127], v184, s[16:19], s34 offen offset:128 sc1
    s_add_u32 s34, s34, 2048
    v_xor_b32 v2, 192, v183
    ds_read_b64_tr_b16 v[136:137], v2 offset:0
    ds_read_b64_tr_b16 v[138:139], v2 offset:16384
    ds_read_b64_tr_b16 v[140:141], v2 offset:1024
    ds_read_b64_tr_b16 v[142:143], v2 offset:17408
    s_waitcnt lgkmcnt(4)
    buffer_store_dwordx4 v[128:131], v184, s[16:19], s34 offen offset:0 sc1
    buffer_store_dwordx4 v[132:135], v184, s[16:19], s34 offen offset:128 sc1
    s_add_u32 s34, s34, 2048
    v_xor_b32 v2, 224, v183
    ds_read_b64_tr_b16 v[144:145], v2 offset:0
    ds_read_b64_tr_b16 v[146:147], v2 offset:16384
    ds_read_b64_tr_b16 v[148:149], v2 offset:1024
    ds_read_b64_tr_b16 v[150:151], v2 offset:17408
    s_waitcnt lgkmcnt(4)
    buffer_store_dwordx4 v[136:139], v184, s[16:19], s34 offen offset:0 sc1
    buffer_store_dwordx4 v[140:143], v184, s[16:19], s34 offen offset:128 sc1
    s_add_u32 s34, s34, 2048
    s_waitcnt lgkmcnt(0)
    buffer_store_dwordx4 v[144:147], v184, s[16:19], s34 offen offset:0 sc1
    buffer_store_dwordx4 v[148:151], v184, s[16:19], s34 offen offset:128 sc1
    v_lshlrev_b32 v156, 16, v152
    v_and_b32 v157, 0xffff0000, v152
    v_lshlrev_b32 v158, 16, v153
    v_and_b32 v159, 0xffff0000, v153
    v_lshlrev_b32 v160, 16, v154
    v_and_b32 v161, 0xffff0000, v154
    v_lshlrev_b32 v162, 16, v155
    v_and_b32 v163, 0xffff0000, v155
    v_lshlrev_b32 v180, 16, v24
    v_and_b32 v181, 0xffff0000, v24
    v_pk_mul_f32 v[180:181], v[180:181], v[156:157]
    v_cvt_pk_bf16_f32 v180, v180, v181
    v_and_b32 v181, 0xffff0000, v180
    v_lshlrev_b32 v180, 16, v180
    v_add_f32 v164, v180, v181
    v_lshlrev_b32 v180, 16, v25
    v_and_b32 v181, 0xffff0000, v25
    v_pk_mul_f32 v[180:181], v[180:181], v[158:159]
    v_cvt_pk_bf16_f32 v180, v180, v181
    v_and_b32 v181, 0xffff0000, v180
    v_lshlrev_b32 v180, 16, v180
    v_add_f32 v164, v164, v180
    v_add_f32 v164, v164, v181
    v_lshlrev_b32 v180, 16, v26
    v_and_b32 v181, 0xffff0000, v26
    v_pk_mul_f32 v[180:181], v[180:181], v[160:161]
    v_cvt_pk_bf16_f32 v180, v180, v181
    v_and_b32 v181, 0xffff0000, v180
    v_lshlrev_b32 v180, 16, v180
    v_add_f32 v164, v164, v180
    v_add_f32 v164, v164, v181
    v_lshlrev_b32 v180, 16, v27
    v_and_b32 v181, 0xffff0000, v27
    v_pk_mul_f32 v[180:181], v[180:181], v[162:163]
    v_cvt_pk_bf16_f32 v180, v180, v181
    v_and_b32 v181, 0xffff0000, v180
    v_lshlrev_b32 v180, 16, v180
    v_add_f32 v164, v164, v180
    v_add_f32 v164, v164, v181
    v_lshlrev_b32 v180, 16, v28
    v_and_b32 v181, 0xffff0000, v28
    v_pk_mul_f32 v[180:181], v[180:181], v[156:157]
    v_cvt_pk_bf16_f32 v180, v180, v181
    v_and_b32 v181, 0xffff0000, v180
    v_lshlrev_b32 v180, 16, v180
    v_add_f32 v165, v180, v181
    v_lshlrev_b32 v180, 16, v29
    v_and_b32 v181, 0xffff0000, v29
    v_pk_mul_f32 v[180:181], v[180:181], v[158:159]
    v_cvt_pk_bf16_f32 v180, v180, v181
    v_and_b32 v181, 0xffff0000, v180
    v_lshlrev_b32 v180, 16, v180
    v_add_f32 v165, v165, v180
    v_add_f32 v165, v165, v181
    v_lshlrev_b32 v180, 16, v30
    v_and_b32 v181, 0xffff0000, v30
    v_pk_mul_f32 v[180:181], v[180:181], v[160:161]
    v_cvt_pk_bf16_f32 v180, v180, v181
    v_and_b32 v181, 0xffff0000, v180
    v_lshlrev_b32 v180, 16, v180
    v_add_f32 v165, v165, v180
    v_add_f32 v165, v165, v181
    v_lshlrev_b32 v180, 16, v31
    v_and_b32 v181, 0xffff0000, v31
    v_pk_mul_f32 v[180:181], v[180:181], v[162:163]
    v_cvt_pk_bf16_f32 v180, v180, v181
    v_and_b32 v181, 0xffff0000, v180
    v_lshlrev_b32 v180, 16, v180
    v_add_f32 v165, v165, v180
    v_add_f32 v165, v165, v181
    v_lshlrev_b32 v180, 16, v32
    v_and_b32 v181, 0xffff0000, v32
    v_pk_mul_f32 v[180:181], v[180:181], v[156:157]
    v_cvt_pk_bf16_f32 v180, v180, v181
    v_and_b32 v181, 0xffff0000, v180
    v_lshlrev_b32 v180, 16, v180
    v_add_f32 v166, v180, v181
    v_lshlrev_b32 v180, 16, v33
    v_and_b32 v181, 0xffff0000, v33
    v_pk_mul_f32 v[180:181], v[180:181], v[158:159]
    v_cvt_pk_bf16_f32 v180, v180, v181
    v_and_b32 v181, 0xffff0000, v180
    v_lshlrev_b32 v180, 16, v180
    v_add_f32 v166, v166, v180
    v_add_f32 v166, v166, v181
    v_lshlrev_b32 v180, 16, v34
    v_and_b32 v181, 0xffff0000, v34
    v_pk_mul_f32 v[180:181], v[180:181], v[160:161]
    v_cvt_pk_bf16_f32 v180, v180, v181
    v_and_b32 v181, 0xffff0000, v180
    v_lshlrev_b32 v180, 16, v180
    v_add_f32 v166, v166, v180
    v_add_f32 v166, v166, v181
    v_lshlrev_b32 v180, 16, v35
    v_and_b32 v181, 0xffff0000, v35
    v_pk_mul_f32 v[180:181], v[180:181], v[162:163]
    v_cvt_pk_bf16_f32 v180, v180, v181
    v_and_b32 v181, 0xffff0000, v180
    v_lshlrev_b32 v180, 16, v180
    v_add_f32 v166, v166, v180
    v_add_f32 v166, v166, v181
    v_lshlrev_b32 v180, 16, v36
    v_and_b32 v181, 0xffff0000, v36
    v_pk_mul_f32 v[180:181], v[180:181], v[156:157]
    v_cvt_pk_bf16_f32 v180, v180, v181
    v_and_b32 v181, 0xffff0000, v180
    v_lshlrev_b32 v180, 16, v180
    v_add_f32 v167, v180, v181
    v_lshlrev_b32 v180, 16, v37
    v_and_b32 v181, 0xffff0000, v37
    v_pk_mul_f32 v[180:181], v[180:181], v[158:159]
    v_cvt_pk_bf16_f32 v180, v180, v181
    v_and_b32 v181, 0xffff0000, v180
    v_lshlrev_b32 v180, 16, v180
    v_add_f32 v167, v167, v180
    v_add_f32 v167, v167, v181
    v_lshlrev_b32 v180, 16, v38
    v_and_b32 v181, 0xffff0000, v38
    v_pk_mul_f32 v[180:181], v[180:181], v[160:161]
    v_cvt_pk_bf16_f32 v180, v180, v181
    v_and_b32 v181, 0xffff0000, v180
    v_lshlrev_b32 v180, 16, v180
    v_add_f32 v167, v167, v180
    v_add_f32 v167, v167, v181
    v_lshlrev_b32 v180, 16, v39
    v_and_b32 v181, 0xffff0000, v39
    v_pk_mul_f32 v[180:181], v[180:181], v[162:163]
    v_cvt_pk_bf16_f32 v180, v180, v181
    v_and_b32 v181, 0xffff0000, v180
    v_lshlrev_b32 v180, 16, v180
    v_add_f32 v167, v167, v180
    v_add_f32 v167, v167, v181
    v_lshlrev_b32 v180, 16, v40
    v_and_b32 v181, 0xffff0000, v40
    v_pk_mul_f32 v[180:181], v[180:181], v[156:157]
    v_cvt_pk_bf16_f32 v180, v180, v181
    v_and_b32 v181, 0xffff0000, v180
    v_lshlrev_b32 v180, 16, v180
    v_add_f32 v168, v180, v181
    v_lshlrev_b32 v180, 16, v41
    v_and_b32 v181, 0xffff0000, v41
    v_pk_mul_f32 v[180:181], v[180:181], v[158:159]
    v_cvt_pk_bf16_f32 v180, v180, v181
    v_and_b32 v181, 0xffff0000, v180
    v_lshlrev_b32 v180, 16, v180
    v_add_f32 v168, v168, v180
    v_add_f32 v168, v168, v181
    v_lshlrev_b32 v180, 16, v42
    v_and_b32 v181, 0xffff0000, v42
    v_pk_mul_f32 v[180:181], v[180:181], v[160:161]
    v_cvt_pk_bf16_f32 v180, v180, v181
    v_and_b32 v181, 0xffff0000, v180
    v_lshlrev_b32 v180, 16, v180
    v_add_f32 v168, v168, v180
    v_add_f32 v168, v168, v181
    v_lshlrev_b32 v180, 16, v43
    v_and_b32 v181, 0xffff0000, v43
    v_pk_mul_f32 v[180:181], v[180:181], v[162:163]
    v_cvt_pk_bf16_f32 v180, v180, v181
    v_and_b32 v181, 0xffff0000, v180
    v_lshlrev_b32 v180, 16, v180
    v_add_f32 v168, v168, v180
    v_add_f32 v168, v168, v181
    v_lshlrev_b32 v180, 16, v44
    v_and_b32 v181, 0xffff0000, v44
    v_pk_mul_f32 v[180:181], v[180:181], v[156:157]
    v_cvt_pk_bf16_f32 v180, v180, v181
    v_and_b32 v181, 0xffff0000, v180
    v_lshlrev_b32 v180, 16, v180
    v_add_f32 v169, v180, v181
    v_lshlrev_b32 v180, 16, v45
    v_and_b32 v181, 0xffff0000, v45
    v_pk_mul_f32 v[180:181], v[180:181], v[158:159]
    v_cvt_pk_bf16_f32 v180, v180, v181
    v_and_b32 v181, 0xffff0000, v180
    v_lshlrev_b32 v180, 16, v180
    v_add_f32 v169, v169, v180
    v_add_f32 v169, v169, v181
    v_lshlrev_b32 v180, 16, v46
    v_and_b32 v181, 0xffff0000, v46
    v_pk_mul_f32 v[180:181], v[180:181], v[160:161]
    v_cvt_pk_bf16_f32 v180, v180, v181
    v_and_b32 v181, 0xffff0000, v180
    v_lshlrev_b32 v180, 16, v180
    v_add_f32 v169, v169, v180
    v_add_f32 v169, v169, v181
    v_lshlrev_b32 v180, 16, v47
    v_and_b32 v181, 0xffff0000, v47
    v_pk_mul_f32 v[180:181], v[180:181], v[162:163]
    v_cvt_pk_bf16_f32 v180, v180, v181
    v_and_b32 v181, 0xffff0000, v180
    v_lshlrev_b32 v180, 16, v180
    v_add_f32 v169, v169, v180
    v_add_f32 v169, v169, v181
    s_barrier
    v_lshlrev_b32 v180, 16, v48
    v_and_b32 v181, 0xffff0000, v48
    v_pk_mul_f32 v[180:181], v[180:181], v[156:157]
    v_cvt_pk_bf16_f32 v180, v180, v181
    v_and_b32 v181, 0xffff0000, v180
    v_lshlrev_b32 v180, 16, v180
    v_add_f32 v170, v180, v181
    v_lshlrev_b32 v180, 16, v49
    v_and_b32 v181, 0xffff0000, v49
    v_pk_mul_f32 v[180:181], v[180:181], v[158:159]
    v_cvt_pk_bf16_f32 v180, v180, v181
    v_and_b32 v181, 0xffff0000, v180
    v_lshlrev_b32 v180, 16, v180
    v_add_f32 v170, v170, v180
    v_add_f32 v170, v170, v181
    v_lshlrev_b32 v180, 16, v50
    v_and_b32 v181, 0xffff0000, v50
    v_pk_mul_f32 v[180:181], v[180:181], v[160:161]
    v_cvt_pk_bf16_f32 v180, v180, v181
    v_and_b32 v181, 0xffff0000, v180
    v_lshlrev_b32 v180, 16, v180
    v_add_f32 v170, v170, v180
    v_add_f32 v170, v170, v181
    v_lshlrev_b32 v180, 16, v51
    v_and_b32 v181, 0xffff0000, v51
    v_pk_mul_f32 v[180:181], v[180:181], v[162:163]
    v_cvt_pk_bf16_f32 v180, v180, v181
    v_and_b32 v181, 0xffff0000, v180
    v_lshlrev_b32 v180, 16, v180
    v_add_f32 v170, v170, v180
    v_add_f32 v170, v170, v181
    v_lshlrev_b32 v180, 16, v52
    v_and_b32 v181, 0xffff0000, v52
    v_pk_mul_f32 v[180:181], v[180:181], v[156:157]
    v_cvt_pk_bf16_f32 v180, v180, v181
    v_and_b32 v181, 0xffff0000, v180
    v_lshlrev_b32 v180, 16, v180
    v_add_f32 v171, v180, v181
    v_lshlrev_b32 v180, 16, v53
    v_and_b32 v181, 0xffff0000, v53
    v_pk_mul_f32 v[180:181], v[180:181], v[158:159]
    v_cvt_pk_bf16_f32 v180, v180, v181
    v_and_b32 v181, 0xffff0000, v180
    v_lshlrev_b32 v180, 16, v180
    v_add_f32 v171, v171, v180
    v_add_f32 v171, v171, v181
    v_lshlrev_b32 v180, 16, v54
    v_and_b32 v181, 0xffff0000, v54
    v_pk_mul_f32 v[180:181], v[180:181], v[160:161]
    v_cvt_pk_bf16_f32 v180, v180, v181
    v_and_b32 v181, 0xffff0000, v180
    v_lshlrev_b32 v180, 16, v180
    v_add_f32 v171, v171, v180
    v_add_f32 v171, v171, v181
    v_lshlrev_b32 v180, 16, v55
    v_and_b32 v181, 0xffff0000, v55
    v_pk_mul_f32 v[180:181], v[180:181], v[162:163]
    v_cvt_pk_bf16_f32 v180, v180, v181
    v_and_b32 v181, 0xffff0000, v180
    v_lshlrev_b32 v180, 16, v180
    v_add_f32 v171, v171, v180
    v_add_f32 v171, v171, v181
    v_lshlrev_b32 v180, 16, v56
    v_and_b32 v181, 0xffff0000, v56
    v_pk_mul_f32 v[180:181], v[180:181], v[156:157]
    v_cvt_pk_bf16_f32 v180, v180, v181
    v_and_b32 v181, 0xffff0000, v180
    v_lshlrev_b32 v180, 16, v180
    v_add_f32 v172, v180, v181
    v_lshlrev_b32 v180, 16, v57
    v_and_b32 v181, 0xffff0000, v57
    v_pk_mul_f32 v[180:181], v[180:181], v[158:159]
    v_cvt_pk_bf16_f32 v180, v180, v181
    v_and_b32 v181, 0xffff0000, v180
    v_lshlrev_b32 v180, 16, v180
    v_add_f32 v172, v172, v180
    v_add_f32 v172, v172, v181
    v_lshlrev_b32 v180, 16, v58
    v_and_b32 v181, 0xffff0000, v58
    v_pk_mul_f32 v[180:181], v[180:181], v[160:161]
    v_cvt_pk_bf16_f32 v180, v180, v181
    v_and_b32 v181, 0xffff0000, v180
    v_lshlrev_b32 v180, 16, v180
    v_add_f32 v172, v172, v180
    v_add_f32 v172, v172, v181
    v_lshlrev_b32 v180, 16, v59
    v_and_b32 v181, 0xffff0000, v59
    v_pk_mul_f32 v[180:181], v[180:181], v[162:163]
    v_cvt_pk_bf16_f32 v180, v180, v181
    v_and_b32 v181, 0xffff0000, v180
    v_lshlrev_b32 v180, 16, v180
    v_add_f32 v172, v172, v180
    v_add_f32 v172, v172, v181
    v_lshlrev_b32 v180, 16, v60
    v_and_b32 v181, 0xffff0000, v60
    v_pk_mul_f32 v[180:181], v[180:181], v[156:157]
    v_cvt_pk_bf16_f32 v180, v180, v181
    v_and_b32 v181, 0xffff0000, v180
    v_lshlrev_b32 v180, 16, v180
    v_add_f32 v173, v180, v181
    v_lshlrev_b32 v180, 16, v61
    v_and_b32 v181, 0xffff0000, v61
    v_pk_mul_f32 v[180:181], v[180:181], v[158:159]
    v_cvt_pk_bf16_f32 v180, v180, v181
    v_and_b32 v181, 0xffff0000, v180
    v_lshlrev_b32 v180, 16, v180
    v_add_f32 v173, v173, v180
    v_add_f32 v173, v173, v181
    v_lshlrev_b32 v180, 16, v62
    v_and_b32 v181, 0xffff0000, v62
    v_pk_mul_f32 v[180:181], v[180:181], v[160:161]
    v_cvt_pk_bf16_f32 v180, v180, v181
    v_and_b32 v181, 0xffff0000, v180
    v_lshlrev_b32 v180, 16, v180
    v_add_f32 v173, v173, v180
    v_add_f32 v173, v173, v181
    v_lshlrev_b32 v180, 16, v63
    v_and_b32 v181, 0xffff0000, v63
    v_pk_mul_f32 v[180:181], v[180:181], v[162:163]
    v_cvt_pk_bf16_f32 v180, v180, v181
    v_and_b32 v181, 0xffff0000, v180
    v_lshlrev_b32 v180, 16, v180
    v_add_f32 v173, v173, v180
    v_add_f32 v173, v173, v181
    s_waitcnt vmcnt(0)
    s_mov_b32 s75, 0
Ltok6:
    v_readfirstlane_b32 s68, v12
    s_add_u32 s75, s75, 1
    s_cmp_lg_u32 s68, 0
    s_cbranch_scc1 Ltok6_ok
    global_load_dword v12, v13, s[66:67] sc1
    s_waitcnt vmcnt(0)
    s_cmp_lt_u32 s75, 131072
    s_cbranch_scc1 Ltok6
Ltok6_ok:
    s_lshl_b32 s34, s69, 7
    s_lshl_b32 s35, s70, 2
    s_add_u32 s34, s34, s35
    s_add_u32 s34, s34, 16252928
    s_mov_b64 exec, 1
    buffer_store_dword v12, v13, s[16:19], s34 offen sc1
    s_mov_b64 exec, -1
    s_mov_b64 exec, 1
    ds_add_u32 v7, v8 offset:16
    s_mov_b64 exec, -1
    s_barrier
    v_lshlrev_b32 v180, 16, v64
    v_and_b32 v181, 0xffff0000, v64
    v_pk_mul_f32 v[180:181], v[180:181], v[156:157]
    v_cvt_pk_bf16_f32 v180, v180, v181
    v_and_b32 v181, 0xffff0000, v180
    v_lshlrev_b32 v180, 16, v180
    v_add_f32 v174, v180, v181
    v_lshlrev_b32 v180, 16, v65
    v_and_b32 v181, 0xffff0000, v65
    v_pk_mul_f32 v[180:181], v[180:181], v[158:159]
    v_cvt_pk_bf16_f32 v180, v180, v181
    v_and_b32 v181, 0xffff0000, v180
    v_lshlrev_b32 v180, 16, v180
    v_add_f32 v174, v174, v180
    v_add_f32 v174, v174, v181
    v_lshlrev_b32 v180, 16, v66
    v_and_b32 v181, 0xffff0000, v66
    v_pk_mul_f32 v[180:181], v[180:181], v[160:161]
    v_cvt_pk_bf16_f32 v180, v180, v181
    v_and_b32 v181, 0xffff0000, v180
    v_lshlrev_b32 v180, 16, v180
    v_add_f32 v174, v174, v180
    v_add_f32 v174, v174, v181
    v_lshlrev_b32 v180, 16, v67
    v_and_b32 v181, 0xffff0000, v67
    v_pk_mul_f32 v[180:181], v[180:181], v[162:163]
    v_cvt_pk_bf16_f32 v180, v180, v181
    v_and_b32 v181, 0xffff0000, v180
    v_lshlrev_b32 v180, 16, v180
    v_add_f32 v174, v174, v180
    v_add_f32 v174, v174, v181
    v_lshlrev_b32 v180, 16, v68
    v_and_b32 v181, 0xffff0000, v68
    v_pk_mul_f32 v[180:181], v[180:181], v[156:157]
    v_cvt_pk_bf16_f32 v180, v180, v181
    v_and_b32 v181, 0xffff0000, v180
    v_lshlrev_b32 v180, 16, v180
    v_add_f32 v175, v180, v181
    v_lshlrev_b32 v180, 16, v69
    v_and_b32 v181, 0xffff0000, v69
    v_pk_mul_f32 v[180:181], v[180:181], v[158:159]
    v_cvt_pk_bf16_f32 v180, v180, v181
    v_and_b32 v181, 0xffff0000, v180
    v_lshlrev_b32 v180, 16, v180
    v_add_f32 v175, v175, v180
    v_add_f32 v175, v175, v181
    v_lshlrev_b32 v180, 16, v70
    v_and_b32 v181, 0xffff0000, v70
    v_pk_mul_f32 v[180:181], v[180:181], v[160:161]
    v_cvt_pk_bf16_f32 v180, v180, v181
    v_and_b32 v181, 0xffff0000, v180
    v_lshlrev_b32 v180, 16, v180
    v_add_f32 v175, v175, v180
    v_add_f32 v175, v175, v181
    v_lshlrev_b32 v180, 16, v71
    v_and_b32 v181, 0xffff0000, v71
    v_pk_mul_f32 v[180:181], v[180:181], v[162:163]
    v_cvt_pk_bf16_f32 v180, v180, v181
    v_and_b32 v181, 0xffff0000, v180
    v_lshlrev_b32 v180, 16, v180
    v_add_f32 v175, v175, v180
    v_add_f32 v175, v175, v181
    v_lshlrev_b32 v180, 16, v72
    v_and_b32 v181, 0xffff0000, v72
    v_pk_mul_f32 v[180:181], v[180:181], v[156:157]
    v_cvt_pk_bf16_f32 v180, v180, v181
    v_and_b32 v181, 0xffff0000, v180
    v_lshlrev_b32 v180, 16, v180
    v_add_f32 v176, v180, v181
    v_lshlrev_b32 v180, 16, v73
    v_and_b32 v181, 0xffff0000, v73
    v_pk_mul_f32 v[180:181], v[180:181], v[158:159]
    v_cvt_pk_bf16_f32 v180, v180, v181
    v_and_b32 v181, 0xffff0000, v180
    v_lshlrev_b32 v180, 16, v180
    v_add_f32 v176, v176, v180
    v_add_f32 v176, v176, v181
    v_lshlrev_b32 v180, 16, v74
    v_and_b32 v181, 0xffff0000, v74
    v_pk_mul_f32 v[180:181], v[180:181], v[160:161]
    v_cvt_pk_bf16_f32 v180, v180, v181
    v_and_b32 v181, 0xffff0000, v180
    v_lshlrev_b32 v180, 16, v180
    v_add_f32 v176, v176, v180
    v_add_f32 v176, v176, v181
    v_lshlrev_b32 v180, 16, v75
    v_and_b32 v181, 0xffff0000, v75
    v_pk_mul_f32 v[180:181], v[180:181], v[162:163]
    v_cvt_pk_bf16_f32 v180, v180, v181
    v_and_b32 v181, 0xffff0000, v180
    v_lshlrev_b32 v180, 16, v180
    v_add_f32 v176, v176, v180
    v_add_f32 v176, v176, v181
    v_lshlrev_b32 v180, 16, v76
    v_and_b32 v181, 0xffff0000, v76
    v_pk_mul_f32 v[180:181], v[180:181], v[156:157]
    v_cvt_pk_bf16_f32 v180, v180, v181
    v_and_b32 v181, 0xffff0000, v180
    v_lshlrev_b32 v180, 16, v180
    v_add_f32 v177, v180, v181
    v_lshlrev_b32 v180, 16, v77
    v_and_b32 v181, 0xffff0000, v77
    v_pk_mul_f32 v[180:181], v[180:181], v[158:159]
    v_cvt_pk_bf16_f32 v180, v180, v181
    v_and_b32 v181, 0xffff0000, v180
    v_lshlrev_b32 v180, 16, v180
    v_add_f32 v177, v177, v180
    v_add_f32 v177, v177, v181
    v_lshlrev_b32 v180, 16, v78
    v_and_b32 v181, 0xffff0000, v78
    v_pk_mul_f32 v[180:181], v[180:181], v[160:161]
    v_cvt_pk_bf16_f32 v180, v180, v181
    v_and_b32 v181, 0xffff0000, v180
    v_lshlrev_b32 v180, 16, v180
    v_add_f32 v177, v177, v180
    v_add_f32 v177, v177, v181
    v_lshlrev_b32 v180, 16, v79
    v_and_b32 v181, 0xffff0000, v79
    v_pk_mul_f32 v[180:181], v[180:181], v[162:163]
    v_cvt_pk_bf16_f32 v180, v180, v181
    v_and_b32 v181, 0xffff0000, v180
    v_lshlrev_b32 v180, 16, v180
    v_add_f32 v177, v177, v180
    v_add_f32 v177, v177, v181
    v_lshlrev_b32 v180, 16, v80
    v_and_b32 v181, 0xffff0000, v80
    v_pk_mul_f32 v[180:181], v[180:181], v[156:157]
    v_cvt_pk_bf16_f32 v180, v180, v181
    v_and_b32 v181, 0xffff0000, v180
    v_lshlrev_b32 v180, 16, v180
    v_add_f32 v178, v180, v181
    v_lshlrev_b32 v180, 16, v81
    v_and_b32 v181, 0xffff0000, v81
    v_pk_mul_f32 v[180:181], v[180:181], v[158:159]
    v_cvt_pk_bf16_f32 v180, v180, v181
    v_and_b32 v181, 0xffff0000, v180
    v_lshlrev_b32 v180, 16, v180
    v_add_f32 v178, v178, v180
    v_add_f32 v178, v178, v181
    v_lshlrev_b32 v180, 16, v82
    v_and_b32 v181, 0xffff0000, v82
    v_pk_mul_f32 v[180:181], v[180:181], v[160:161]
    v_cvt_pk_bf16_f32 v180, v180, v181
    v_and_b32 v181, 0xffff0000, v180
    v_lshlrev_b32 v180, 16, v180
    v_add_f32 v178, v178, v180
    v_add_f32 v178, v178, v181
    v_lshlrev_b32 v180, 16, v83
    v_and_b32 v181, 0xffff0000, v83
    v_pk_mul_f32 v[180:181], v[180:181], v[162:163]
    v_cvt_pk_bf16_f32 v180, v180, v181
    v_and_b32 v181, 0xffff0000, v180
    v_lshlrev_b32 v180, 16, v180
    v_add_f32 v178, v178, v180
    v_add_f32 v178, v178, v181
    v_lshlrev_b32 v180, 16, v84
    v_and_b32 v181, 0xffff0000, v84
    v_pk_mul_f32 v[180:181], v[180:181], v[156:157]
    v_cvt_pk_bf16_f32 v180, v180, v181
    v_and_b32 v181, 0xffff0000, v180
    v_lshlrev_b32 v180, 16, v180
    v_add_f32 v179, v180, v181
    v_lshlrev_b32 v180, 16, v85
    v_and_b32 v181, 0xffff0000, v85
    v_pk_mul_f32 v[180:181], v[180:181], v[158:159]
    v_cvt_pk_bf16_f32 v180, v180, v181
    v_and_b32 v181, 0xffff0000, v180
    v_lshlrev_b32 v180, 16, v180
    v_add_f32 v179, v179, v180
    v_add_f32 v179, v179, v181
    v_lshlrev_b32 v180, 16, v86
    v_and_b32 v181, 0xffff0000, v86
    v_pk_mul_f32 v[180:181], v[180:181], v[160:161]
    v_cvt_pk_bf16_f32 v180, v180, v181
    v_and_b32 v181, 0xffff0000, v180
    v_lshlrev_b32 v180, 16, v180
    v_add_f32 v179, v179, v180
    v_add_f32 v179, v179, v181
    v_lshlrev_b32 v180, 16, v87
    v_and_b32 v181, 0xffff0000, v87
    v_pk_mul_f32 v[180:181], v[180:181], v[162:163]
    v_cvt_pk_bf16_f32 v180, v180, v181
    v_and_b32 v181, 0xffff0000, v180
    v_lshlrev_b32 v180, 16, v180
    v_add_f32 v179, v179, v180
    v_add_f32 v179, v179, v181
    v_add_f32_dpp v164, v164, v164 quad_perm:[1,0,3,2] row_mask:0xf bank_mask:0xf
    v_add_f32_dpp v165, v165, v165 quad_perm:[1,0,3,2] row_mask:0xf bank_mask:0xf
    v_add_f32_dpp v166, v166, v166 quad_perm:[1,0,3,2] row_mask:0xf bank_mask:0xf
    v_add_f32_dpp v167, v167, v167 quad_perm:[1,0,3,2] row_mask:0xf bank_mask:0xf
    v_add_f32_dpp v168, v168, v168 quad_perm:[1,0,3,2] row_mask:0xf bank_mask:0xf
    v_add_f32_dpp v169, v169, v169 quad_perm:[1,0,3,2] row_mask:0xf bank_mask:0xf
    v_add_f32_dpp v170, v170, v170 quad_perm:[1,0,3,2] row_mask:0xf bank_mask:0xf
    v_add_f32_dpp v171, v171, v171 quad_perm:[1,0,3,2] row_mask:0xf bank_mask:0xf
    v_add_f32_dpp v172, v172, v172 quad_perm:[1,0,3,2] row_mask:0xf bank_mask:0xf
    v_add_f32_dpp v173, v173, v173 quad_perm:[1,0,3,2] row_mask:0xf bank_mask:0xf
    v_add_f32_dpp v174, v174, v174 quad_perm:[1,0,3,2] row_mask:0xf bank_mask:0xf
    v_add_f32_dpp v175, v175, v175 quad_perm:[1,0,3,2] row_mask:0xf bank_mask:0xf
    v_add_f32_dpp v176, v176, v176 quad_perm:[1,0,3,2] row_mask:0xf bank_mask:0xf
    v_add_f32_dpp v177, v177, v177 quad_perm:[1,0,3,2] row_mask:0xf bank_mask:0xf
    v_add_f32_dpp v178, v178, v178 quad_perm:[1,0,3,2] row_mask:0xf bank_mask:0xf
    v_add_f32_dpp v179, v179, v179 quad_perm:[1,0,3,2] row_mask:0xf bank_mask:0xf
    v_add_f32_dpp v164, v164, v164 quad_perm:[2,3,0,1] row_mask:0xf bank_mask:0xf
    v_add_f32_dpp v165, v165, v165 quad_perm:[2,3,0,1] row_mask:0xf bank_mask:0xf
    v_add_f32_dpp v166, v166, v166 quad_perm:[2,3,0,1] row_mask:0xf bank_mask:0xf
    v_add_f32_dpp v167, v167, v167 quad_perm:[2,3,0,1] row_mask:0xf bank_mask:0xf
    v_add_f32_dpp v168, v168, v168 quad_perm:[2,3,0,1] row_mask:0xf bank_mask:0xf
    v_add_f32_dpp v169, v169, v169 quad_perm:[2,3,0,1] row_mask:0xf bank_mask:0xf
    v_add_f32_dpp v170, v170, v170 quad_perm:[2,3,0,1] row_mask:0xf bank_mask:0xf
    v_add_f32_dpp v171, v171, v171 quad_perm:[2,3,0,1] row_mask:0xf bank_mask:0xf
    v_add_f32_dpp v172, v172, v172 quad_perm:[2,3,0,1] row_mask:0xf bank_mask:0xf
    v_add_f32_dpp v173, v173, v173 quad_perm:[2,3,0,1] row_mask:0xf bank_mask:0xf
    v_add_f32_dpp v174, v174, v174 quad_perm:[2,3,0,1] row_mask:0xf bank_mask:0xf
    v_add_f32_dpp v175, v175, v175 quad_perm:[2,3,0,1] row_mask:0xf bank_mask:0xf
    v_add_f32_dpp v176, v176, v176 quad_perm:[2,3,0,1] row_mask:0xf bank_mask:0xf
    v_add_f32_dpp v177, v177, v177 quad_perm:[2,3,0,1] row_mask:0xf bank_mask:0xf
    v_add_f32_dpp v178, v178, v178 quad_perm:[2,3,0,1] row_mask:0xf bank_mask:0xf
    v_add_f32_dpp v179, v179, v179 quad_perm:[2,3,0,1] row_mask:0xf bank_mask:0xf
    v_add_f32_dpp v164, v164, v164 row_half_mirror row_mask:0xf bank_mask:0xf
    v_add_f32_dpp v165, v165, v165 row_half_mirror row_mask:0xf bank_mask:0xf
    v_add_f32_dpp v166, v166, v166 row_half_mirror row_mask:0xf bank_mask:0xf
    v_add_f32_dpp v167, v167, v167 row_half_mirror row_mask:0xf bank_mask:0xf
    v_add_f32_dpp v168, v168, v168 row_half_mirror row_mask:0xf bank_mask:0xf
    v_add_f32_dpp v169, v169, v169 row_half_mirror row_mask:0xf bank_mask:0xf
    v_add_f32_dpp v170, v170, v170 row_half_mirror row_mask:0xf bank_mask:0xf
    v_add_f32_dpp v171, v171, v171 row_half_mirror row_mask:0xf bank_mask:0xf
    v_add_f32_dpp v172, v172, v172 row_half_mirror row_mask:0xf bank_mask:0xf
    v_add_f32_dpp v173, v173, v173 row_half_mirror row_mask:0xf bank_mask:0xf
    v_add_f32_dpp v174, v174, v174 row_half_mirror row_mask:0xf bank_mask:0xf
    v_add_f32_dpp v175, v175, v175 row_half_mirror row_mask:0xf bank_mask:0xf
    v_add_f32_dpp v176, v176, v176 row_half_mirror row_mask:0xf bank_mask:0xf
    v_add_f32_dpp v177, v177, v177 row_half_mirror row_mask:0xf bank_mask:0xf
    v_add_f32_dpp v178, v178, v178 row_half_mirror row_mask:0xf bank_mask:0xf
    v_add_f32_dpp v179, v179, v179 row_half_mirror row_mask:0xf bank_mask:0xf
    v_add_f32_dpp v164, v164, v164 row_mirror row_mask:0xf bank_mask:0xf
    v_add_f32_dpp v165, v165, v165 row_mirror row_mask:0xf bank_mask:0xf
    v_add_f32_dpp v166, v166, v166 row_mirror row_mask:0xf bank_mask:0xf
    v_add_f32_dpp v167, v167, v167 row_mirror row_mask:0xf bank_mask:0xf
    v_add_f32_dpp v168, v168, v168 row_mirror row_mask:0xf bank_mask:0xf
    v_add_f32_dpp v169, v169, v169 row_mirror row_mask:0xf bank_mask:0xf
    v_add_f32_dpp v170, v170, v170 row_mirror row_mask:0xf bank_mask:0xf
    v_add_f32_dpp v171, v171, v171 row_mirror row_mask:0xf bank_mask:0xf
    v_add_f32_dpp v172, v172, v172 row_mirror row_mask:0xf bank_mask:0xf
    v_add_f32_dpp v173, v173, v173 row_mirror row_mask:0xf bank_mask:0xf
    v_add_f32_dpp v174, v174, v174 row_mirror row_mask:0xf bank_mask:0xf
    v_add_f32_dpp v175, v175, v175 row_mirror row_mask:0xf bank_mask:0xf
    v_add_f32_dpp v176, v176, v176 row_mirror row_mask:0xf bank_mask:0xf
    v_add_f32_dpp v177, v177, v177 row_mirror row_mask:0xf bank_mask:0xf
    v_add_f32_dpp v178, v178, v178 row_mirror row_mask:0xf bank_mask:0xf
    v_add_f32_dpp v179, v179, v179 row_mirror row_mask:0xf bank_mask:0xf
    v_add_f32_dpp v164, v164, v164 row_bcast:15 row_mask:0xa bank_mask:0xf
    v_add_f32_dpp v165, v165, v165 row_bcast:15 row_mask:0xa bank_mask:0xf
    v_add_f32_dpp v166, v166, v166 row_bcast:15 row_mask:0xa bank_mask:0xf
    v_add_f32_dpp v167, v167, v167 row_bcast:15 row_mask:0xa bank_mask:0xf
    v_add_f32_dpp v168, v168, v168 row_bcast:15 row_mask:0xa bank_mask:0xf
    v_add_f32_dpp v169, v169, v169 row_bcast:15 row_mask:0xa bank_mask:0xf
    v_add_f32_dpp v170, v170, v170 row_bcast:15 row_mask:0xa bank_mask:0xf
    v_add_f32_dpp v171, v171, v171 row_bcast:15 row_mask:0xa bank_mask:0xf
    v_add_f32_dpp v172, v172, v172 row_bcast:15 row_mask:0xa bank_mask:0xf
    v_add_f32_dpp v173, v173, v173 row_bcast:15 row_mask:0xa bank_mask:0xf
    v_add_f32_dpp v174, v174, v174 row_bcast:15 row_mask:0xa bank_mask:0xf
    v_add_f32_dpp v175, v175, v175 row_bcast:15 row_mask:0xa bank_mask:0xf
    v_add_f32_dpp v176, v176, v176 row_bcast:15 row_mask:0xa bank_mask:0xf
    v_add_f32_dpp v177, v177, v177 row_bcast:15 row_mask:0xa bank_mask:0xf
    v_add_f32_dpp v178, v178, v178 row_bcast:15 row_mask:0xa bank_mask:0xf
    v_add_f32_dpp v179, v179, v179 row_bcast:15 row_mask:0xa bank_mask:0xf
    v_add_f32_dpp v164, v164, v164 row_bcast:31 row_mask:0xc bank_mask:0xf
    v_add_f32_dpp v165, v165, v165 row_bcast:31 row_mask:0xc bank_mask:0xf
    v_add_f32_dpp v166, v166, v166 row_bcast:31 row_mask:0xc bank_mask:0xf
    v_add_f32_dpp v167, v167, v167 row_bcast:31 row_mask:0xc bank_mask:0xf
    v_add_f32_dpp v168, v168, v168 row_bcast:31 row_mask:0xc bank_mask:0xf
    v_add_f32_dpp v169, v169, v169 row_bcast:31 row_mask:0xc bank_mask:0xf
    v_add_f32_dpp v170, v170, v170 row_bcast:31 row_mask:0xc bank_mask:0xf
    v_add_f32_dpp v171, v171, v171 row_bcast:31 row_mask:0xc bank_mask:0xf
    v_add_f32_dpp v172, v172, v172 row_bcast:31 row_mask:0xc bank_mask:0xf
    v_add_f32_dpp v173, v173, v173 row_bcast:31 row_mask:0xc bank_mask:0xf
    v_add_f32_dpp v174, v174, v174 row_bcast:31 row_mask:0xc bank_mask:0xf
    v_add_f32_dpp v175, v175, v175 row_bcast:31 row_mask:0xc bank_mask:0xf
    v_add_f32_dpp v176, v176, v176 row_bcast:31 row_mask:0xc bank_mask:0xf
    v_add_f32_dpp v177, v177, v177 row_bcast:31 row_mask:0xc bank_mask:0xf
    v_add_f32_dpp v178, v178, v178 row_bcast:31 row_mask:0xc bank_mask:0xf
    v_add_f32_dpp v179, v179, v179 row_bcast:31 row_mask:0xc bank_mask:0xf
    v_readlane_b32 s38, v164, 63
    v_readlane_b32 s39, v165, 63
    v_readlane_b32 s40, v166, 63
    v_readlane_b32 s41, v167, 63
    v_readlane_b32 s42, v168, 63
    v_readlane_b32 s43, v169, 63
    v_readlane_b32 s44, v170, 63
    v_readlane_b32 s45, v171, 63
    v_writelane_b32 v180, s38, 0
    v_writelane_b32 v180, s39, 1
    v_writelane_b32 v180, s40, 2
    v_writelane_b32 v180, s41, 3
    v_writelane_b32 v180, s42, 4
    v_writelane_b32 v180, s43, 5
    v_writelane_b32 v180, s44, 6
    v_writelane_b32 v180, s45, 7
    v_readlane_b32 s38, v172, 63
    v_readlane_b32 s39, v173, 63
    v_readlane_b32 s40, v174, 63
    v_readlane_b32 s41, v175, 63
    v_readlane_b32 s42, v176, 63
    v_readlane_b32 s43, v177, 63
    v_readlane_b32 s44, v178, 63
    v_readlane_b32 s45, v179, 63
    v_writelane_b32 v180, s38, 8
    v_writelane_b32 v180, s39, 9
    v_writelane_b32 v180, s40, 10
    v_writelane_b32 v180, s41, 11
    v_writelane_b32 v180, s42, 12
    v_writelane_b32 v180, s43, 13
    v_writelane_b32 v180, s44, 14
    v_writelane_b32 v180, s45, 15
    v_cvt_pk_bf16_f32 v180, v180, v180
    v_lshlrev_b32 v180, 16, v180
    v_mul_f32 v180, 3216550459, v180
    v_exp_f32 v180, v180
    s_nop 0
    v_add_f32 v180, 1.0, v180
    v_rcp_f32 v180, v180
    s_nop 0
    v_cvt_pk_bf16_f32 v180, v180, v180
    v_lshlrev_b32 v180, 16, v180
    v_mov_b32 v181, v12
    v_lshlrev_b32 v2, 3, v1
    s_lshl_b32 s34, s70, 9
    s_lshl_b32 s35, s69, 7
    s_add_u32 s34, s34, s35
    s_add_u32 s34, s34, 14680064
    s_mov_b64 exec, 0xffff
    buffer_store_dwordx2 v[180:181], v2, s[16:19], s34 offen sc1
    s_mov_b64 exec, -1
    s_getpc_b64 s[38:39]
L_pc2:
    s_sub_u32 s38, s38, L_pc2-gated_mix__ssm_conv_s4__glu_gated_glu__prompt_kernel
    s_subb_u32 s39, s39, 0
    s_lshl_b32 s34, s69, 13
    v_lshlrev_b32 v4, 7, v1
    v_add_u32 v4, s34, v4
    v_min_u32 v4, L_end-gated_mix__ssm_conv_s4__glu_gated_glu__prompt_kernel, v4
    global_load_dword v88, v4, s[38:39] sc1
    s_add_u32 m0, s73, 114688
    s_add_u32 s34, s80, 0
    buffer_load_dwordx4 v11, s[20:23], s34 offen lds
    s_add_u32 m0, s73, 115712
    s_add_u32 s34, s80, 8192
    buffer_load_dwordx4 v11, s[20:23], s34 offen lds
    s_add_u32 m0, s73, 122880
    s_add_u32 s34, s80, 16384
    buffer_load_dwordx4 v11, s[20:23], s34 offen lds
    s_add_u32 m0, s73, 123904
    s_add_u32 s34, s80, 24576
    buffer_load_dwordx4 v11, s[20:23], s34 offen lds
    s_add_u32 m0, s73, 65536
    s_add_u32 s34, s80, 32768
    buffer_load_dwordx4 v11, s[20:23], s34 offen lds
    s_add_u32 m0, s73, 66560
    s_add_u32 s34, s80, 40960
    buffer_load_dwordx4 v11, s[20:23], s34 offen lds
    s_add_u32 m0, s73, 73728
    s_add_u32 s34, s80, 49152
    buffer_load_dwordx4 v11, s[20:23], s34 offen lds
    s_add_u32 m0, s73, 74752
    s_add_u32 s34, s80, 57344
    buffer_load_dwordx4 v11, s[20:23], s34 offen lds
    s_add_u32 m0, s73, 0
    s_add_u32 s34, s81, 0
    buffer_load_dwordx4 v11, s[20:23], s34 offen lds
    s_add_u32 m0, s73, 1024
    s_add_u32 s34, s81, 8192
    buffer_load_dwordx4 v11, s[20:23], s34 offen lds
    s_add_u32 m0, s73, 8192
    s_add_u32 s34, s81, 16384
    buffer_load_dwordx4 v11, s[20:23], s34 offen lds
    s_add_u32 m0, s73, 9216
    s_add_u32 s34, s81, 24576
    buffer_load_dwordx4 v11, s[20:23], s34 offen lds
    s_add_u32 m0, s73, 16384
    s_add_u32 s34, s81, 32768
    buffer_load_dwordx4 v11, s[20:23], s34 offen lds
    s_add_u32 m0, s73, 17408
    s_add_u32 s34, s81, 40960
    buffer_load_dwordx4 v11, s[20:23], s34 offen lds
    s_add_u32 m0, s73, 24576
    s_add_u32 s34, s81, 49152
    buffer_load_dwordx4 v11, s[20:23], s34 offen lds
    s_add_u32 m0, s73, 25600
    s_add_u32 s34, s81, 57344
    buffer_load_dwordx4 v11, s[20:23], s34 offen lds
    s_add_u32 m0, s73, 81920
    s_add_u32 s34, s82, 0
    buffer_load_dwordx4 v11, s[20:23], s34 offen lds
    s_add_u32 m0, s73, 82944
    s_add_u32 s34, s82, 8192
    buffer_load_dwordx4 v11, s[20:23], s34 offen lds
    s_add_u32 m0, s73, 90112
    s_add_u32 s34, s82, 16384
    buffer_load_dwordx4 v11, s[20:23], s34 offen lds
    s_add_u32 m0, s73, 91136
    s_add_u32 s34, s82, 24576
    buffer_load_dwordx4 v11, s[20:23], s34 offen lds
    s_add_u32 m0, s73, 32768
    s_add_u32 s34, s82, 32768
    buffer_load_dwordx4 v11, s[20:23], s34 offen lds
    s_add_u32 m0, s73, 33792
    s_add_u32 s34, s82, 40960
    buffer_load_dwordx4 v11, s[20:23], s34 offen lds
    s_add_u32 m0, s73, 40960
    s_add_u32 s34, s82, 49152
    buffer_load_dwordx4 v11, s[20:23], s34 offen lds
    s_add_u32 m0, s73, 41984
    s_add_u32 s34, s82, 57344
    buffer_load_dwordx4 v11, s[20:23], s34 offen lds
    s_mov_b32 exec_hi, 0
    buffer_load_dword v14, v15, s[16:19], s74 offen sc1
    s_mov_b64 exec, -1
    s_waitcnt vmcnt(0)
    s_mov_b64 exec, 1
    ds_add_u32 v7, v8 offset:0
    s_mov_b64 exec, -1
    s_branch L_tail
L_end:
    s_endpgm
.section .rodata,"a"
.p2align 6
.amdhsa_kernel gated_mix__ssm_conv_s4__glu_gated_glu__prompt_kernel
  .amdhsa_next_free_vgpr 256
  .amdhsa_next_free_sgpr 100
  .amdhsa_accum_offset 256
  .amdhsa_group_segment_fixed_size 0
  .amdhsa_kernarg_size 136
  .amdhsa_user_sgpr_count 2
  .amdhsa_user_sgpr_kernarg_segment_ptr 1
  .amdhsa_system_sgpr_workgroup_id_x 1
.end_amdhsa_kernel
```
